```python
import torch

def _softmax(x, axis=-1):
    return torch.softmax(x, dim=axis)

def _gelu(x):
    return torch.nn.functional.gelu(x, approximate='tanh')

def _silu(x):
    return torch.nn.functional.silu(x)

def _sigmoid(x):
    return torch.sigmoid(x)

def _layernorm(x, axis=-1, eps=1e-05):
    m = x.mean(dim=axis, keepdim=True)
    v = x.var(dim=axis, keepdim=True, unbiased=False)
    return (x - m) / torch.sqrt(v + eps)

def _scatter_add(tgt, idx, src, axis=0):
    return tgt.clone().index_add_(axis, idx, src)

def _segment_sum(src, seg, n):
    out = torch.zeros((n,) + src.shape[1:], dtype=src.dtype)
    return out.index_add_(0, seg, src)

def _pad(x, pw):
    flat = tuple((v for pair in reversed(pw) for v in pair))
    return torch.nn.functional.pad(x, flat)
kernel_name = 'adaLN_cond__gqa_block_cached__glu_gated_bilinear__decode'

def setup_inputs():

    _w = lambda a: (lambda t: t.to(torch.bfloat16) if t.is_floating_point() else t)(torch.as_tensor(a))

    def _A_setup():
        B, Sq, D = (2, 1, 512)
        Hq, Hkv, Sk, Dh = (32, 8, 32768, 128)
        assert Hq % Hkv == 0, (Hq, Hkv)
        return {'x': _w((lambda *s: torch.randn(*s, dtype=torch.bfloat16) * 0.1)(B, Sq, D)), 'k_cache': _w((lambda *s: torch.randn(*s, dtype=torch.bfloat16) * 0.8)(B, Hkv, Sk, Dh)), 'v_cache': _w((lambda *s: torch.randn(*s, dtype=torch.bfloat16) * 12.8)(B, Hkv, Sk, Dh)), 'wq': _w((lambda *s: torch.randn(*s, dtype=torch.bfloat16) * 0.8)(D, Hq * Dh) * D ** (-0.5)), 'wo': _w((lambda *s: torch.randn(*s, dtype=torch.bfloat16) * 12.8)(Hq * Dh, D) * (Hq * Dh) ** (-0.5))}
    _A_in = _A_setup()

    def _B_setup():
        B, S, D, F = (2, 1, 512, 1792)
        return {'x': _w((lambda *s: torch.randn(*s, dtype=torch.bfloat16) * 0.1)(B, S, D)), 'w_gate': _w((lambda *s: torch.randn(*s, dtype=torch.bfloat16) * 12.8)(D, F) * D ** (-0.5)), 'w_up': _w((lambda *s: torch.randn(*s, dtype=torch.bfloat16) * 12.8)(D, F) * D ** (-0.5)), 'w_down': _w((lambda *s: torch.randn(*s, dtype=torch.bfloat16) * 12.8)(F, D) * F ** (-0.5))}
    _B_in = _B_setup()
    return {'A_x': _A_in['x'], 'A_k_cache': _A_in['k_cache'], 'A_v_cache': _A_in['v_cache'], 'A_wq': _A_in['wq'], 'A_wo': _A_in['wo'], 'B_x': _B_in['x'], 'B_w_gate': _B_in['w_gate'], 'B_w_up': _B_in['w_up'], 'B_w_down': _B_in['w_down'], 'c': _w((lambda *s: torch.randn(*s, dtype=torch.bfloat16) * 0.2)(2, 512) * 8.0), 'w_mod': _w((lambda *s: torch.randn(*s, dtype=torch.bfloat16) * 0.2)(512, 6 * 512) * 512 ** (-0.5) * 8.0)}

def reference(A_x, A_k_cache, A_v_cache, A_wq, A_wo, B_x, B_w_gate, B_w_up, B_w_down, c, w_mod):

    def _A_ref(x, k_cache, v_cache, wq, wo):
        B, Sq, D = x.shape
        Hq, Dh = (32, 128)
        Hkv = k_cache.shape[1]
        rep = Hq // Hkv
        q = (lambda x, *d: x.permute(*d))((x @ wq).reshape(B, Sq, Hq, Dh), 0, 2, 1, 3)
        k = (lambda x, n, axis: torch.repeat_interleave(x, n, dim=axis))(k_cache, rep, axis=1)
        v = (lambda x, n, axis: torch.repeat_interleave(x, n, dim=axis))(v_cache, rep, axis=1)
        scores = torch.einsum('bhqd,bhkd->bhqk', q, k) * Dh ** (-0.5)
        p = _softmax(scores, axis=-1)
        o = torch.einsum('bhqk,bhkd->bhqd', p, v)
        return (lambda x, *d: x.permute(*d))(o, 0, 2, 1, 3).reshape(B, Sq, Hq * Dh) @ wo

    def _B_ref(x, w_gate, w_up, w_down):
        g = torch.einsum('bsd,df->bsf', x, w_gate)
        u = torch.einsum('bsd,df->bsf', x, w_up)
        h = g * u
        return torch.einsum('bsf,fd->bsd', h, w_down)
    x = A_x
    mod = (_silu(c) @ w_mod).reshape(c.shape[0], 6, 1, -1)
    sa, ca, ga, sb, cb, gb = (mod[:, 0].clone(), mod[:, 1].clone(), mod[:, 2].clone(), mod[:, 3].clone(), mod[:, 4].clone(), mod[:, 5].clone())
    h = _layernorm(x, axis=-1) * (1 + ca) + sa
    x = x + ga * _A_ref(h, A_k_cache, A_v_cache, A_wq, A_wo)
    h = _layernorm(x, axis=-1) * (1 + cb) + sb
    x = x + gb * _B_ref(h, B_w_gate, B_w_up, B_w_down)
    return x
```

```asm
; @launch kernel=k1_kernel grid=(192,1,1) block=(256,1,1) lds=20480
; @launch kernel=k2_kernel grid=(256,1,1) block=(256,1,1) lds=20480
; @launch kernel=k3_kernel grid=(256,1,1) block=(512,1,1) lds=20480
; @launch kernel=k4_kernel grid=(256,1,1) block=(256,1,1) lds=20480
; @launch kernel=k5_kernel grid=(224,1,1) block=(256,1,1) lds=24576
; @launch kernel=k6_kernel grid=(224,1,1) block=(256,1,1) lds=20480
; @launch kernel=k7_kernel grid=(4,1,1) block=(256,1,1) lds=0
.amdgcn_target "amdgcn-amd-amdhsa--gfx950"
.text
.globl k1_kernel
.p2align 8
.type k1_kernel,@function
k1_kernel:
    s_cmp_ge_u32 s2, 192
    s_cbranch_scc1 K1_END
    s_load_dwordx2 s[4:5], s[0:1], 72
    s_load_dwordx2 s[6:7], s[0:1], 80
    s_load_dwordx2 s[8:9], s[0:1], 104
    s_and_b32 s10, s2, 3
    s_lshr_b32 s11, s2, 2
    v_lshrrev_b32 v1, 3, v0
    v_and_b32 v2, 7, v0
    s_lshl_b32 s12, s10, 7
    v_lshl_add_u32 v3, v1, 2, s12
    v_mul_u32_u24 v4, 0x1800, v3
    s_lshl_b32 s13, s11, 7
    v_lshl_add_u32 v5, v2, 4, s13
    v_add_u32 v4, v4, v5
    v_lshlrev_b32 v6, 1, v3
    s_waitcnt lgkmcnt(0)
    global_load_dwordx4 v[8:11], v4, s[6:7]
    v_add_u32 v4, 0x1800, v4
    global_load_dwordx4 v[12:15], v4, s[6:7]
    v_add_u32 v4, 0x1800, v4
    global_load_dwordx4 v[16:19], v4, s[6:7]
    v_add_u32 v4, 0x1800, v4
    global_load_dwordx4 v[20:23], v4, s[6:7]
    global_load_ushort v24, v6, s[4:5] offset:0
    global_load_ushort v25, v6, s[4:5] offset:2
    global_load_ushort v26, v6, s[4:5] offset:4
    global_load_ushort v27, v6, s[4:5] offset:6
    global_load_ushort v28, v6, s[4:5] offset:1024
    global_load_ushort v29, v6, s[4:5] offset:1026
    global_load_ushort v30, v6, s[4:5] offset:1028
    global_load_ushort v31, v6, s[4:5] offset:1030
    s_lshl_b32 s14, s2, 8
    v_add_u32 v7, s14, v0
    v_cmp_gt_u32 vcc, 0x4000, v7
    v_lshlrev_b32 v7, 2, v7
    v_add_u32 v7, 802816, v7
    v_mov_b32 v41, 0
    s_and_saveexec_b64 s[16:17], vcc
    s_cbranch_execz K1_NOZERO
    global_store_dword v7, v41, s[8:9]
K1_NOZERO:
    s_mov_b64 exec, s[16:17]
    s_waitcnt vmcnt(0)
    v_lshlrev_b32 v24, 16, v24
    v_mul_f32 v41, 0xbfb8aa3b, v24
    v_exp_f32 v41, v41
    s_nop 0
    v_add_f32 v41, 1.0, v41
    v_rcp_f32 v41, v41
    s_nop 0
    v_mul_f32 v24, v24, v41
    v_cvt_pk_bf16_f32 v24, v24, v24
    v_and_b32 v24, 0xffff0000, v24
    v_lshlrev_b32 v25, 16, v25
    v_mul_f32 v41, 0xbfb8aa3b, v25
    v_exp_f32 v41, v41
    s_nop 0
    v_add_f32 v41, 1.0, v41
    v_rcp_f32 v41, v41
    s_nop 0
    v_mul_f32 v25, v25, v41
    v_cvt_pk_bf16_f32 v25, v25, v25
    v_and_b32 v25, 0xffff0000, v25
    v_lshlrev_b32 v26, 16, v26
    v_mul_f32 v41, 0xbfb8aa3b, v26
    v_exp_f32 v41, v41
    s_nop 0
    v_add_f32 v41, 1.0, v41
    v_rcp_f32 v41, v41
    s_nop 0
    v_mul_f32 v26, v26, v41
    v_cvt_pk_bf16_f32 v26, v26, v26
    v_and_b32 v26, 0xffff0000, v26
    v_lshlrev_b32 v27, 16, v27
    v_mul_f32 v41, 0xbfb8aa3b, v27
    v_exp_f32 v41, v41
    s_nop 0
    v_add_f32 v41, 1.0, v41
    v_rcp_f32 v41, v41
    s_nop 0
    v_mul_f32 v27, v27, v41
    v_cvt_pk_bf16_f32 v27, v27, v27
    v_and_b32 v27, 0xffff0000, v27
    v_lshlrev_b32 v28, 16, v28
    v_mul_f32 v41, 0xbfb8aa3b, v28
    v_exp_f32 v41, v41
    s_nop 0
    v_add_f32 v41, 1.0, v41
    v_rcp_f32 v41, v41
    s_nop 0
    v_mul_f32 v28, v28, v41
    v_cvt_pk_bf16_f32 v28, v28, v28
    v_and_b32 v28, 0xffff0000, v28
    v_lshlrev_b32 v29, 16, v29
    v_mul_f32 v41, 0xbfb8aa3b, v29
    v_exp_f32 v41, v41
    s_nop 0
    v_add_f32 v41, 1.0, v41
    v_rcp_f32 v41, v41
    s_nop 0
    v_mul_f32 v29, v29, v41
    v_cvt_pk_bf16_f32 v29, v29, v29
    v_and_b32 v29, 0xffff0000, v29
    v_lshlrev_b32 v30, 16, v30
    v_mul_f32 v41, 0xbfb8aa3b, v30
    v_exp_f32 v41, v41
    s_nop 0
    v_add_f32 v41, 1.0, v41
    v_rcp_f32 v41, v41
    s_nop 0
    v_mul_f32 v30, v30, v41
    v_cvt_pk_bf16_f32 v30, v30, v30
    v_and_b32 v30, 0xffff0000, v30
    v_lshlrev_b32 v31, 16, v31
    v_mul_f32 v41, 0xbfb8aa3b, v31
    v_exp_f32 v41, v41
    s_nop 0
    v_add_f32 v41, 1.0, v41
    v_rcp_f32 v41, v41
    s_nop 0
    v_mul_f32 v31, v31, v41
    v_cvt_pk_bf16_f32 v31, v31, v31
    v_and_b32 v31, 0xffff0000, v31
    v_mov_b32 v44, 0
    v_mov_b32 v45, 0
    v_mov_b32 v46, 0
    v_mov_b32 v47, 0
    v_mov_b32 v48, 0
    v_mov_b32 v49, 0
    v_mov_b32 v50, 0
    v_mov_b32 v51, 0
    v_mov_b32 v52, 0
    v_mov_b32 v53, 0
    v_mov_b32 v54, 0
    v_mov_b32 v55, 0
    v_mov_b32 v56, 0
    v_mov_b32 v57, 0
    v_mov_b32 v58, 0
    v_mov_b32 v59, 0
    v_lshlrev_b32 v41, 16, v8
    v_and_b32 v42, 0xffff0000, v8
    v_fmac_f32 v44, v24, v41
    v_fmac_f32 v45, v24, v42
    v_fmac_f32 v52, v28, v41
    v_fmac_f32 v53, v28, v42
    v_lshlrev_b32 v41, 16, v9
    v_and_b32 v42, 0xffff0000, v9
    v_fmac_f32 v46, v24, v41
    v_fmac_f32 v47, v24, v42
    v_fmac_f32 v54, v28, v41
    v_fmac_f32 v55, v28, v42
    v_lshlrev_b32 v41, 16, v10
    v_and_b32 v42, 0xffff0000, v10
    v_fmac_f32 v48, v24, v41
    v_fmac_f32 v49, v24, v42
    v_fmac_f32 v56, v28, v41
    v_fmac_f32 v57, v28, v42
    v_lshlrev_b32 v41, 16, v11
    v_and_b32 v42, 0xffff0000, v11
    v_fmac_f32 v50, v24, v41
    v_fmac_f32 v51, v24, v42
    v_fmac_f32 v58, v28, v41
    v_fmac_f32 v59, v28, v42
    v_lshlrev_b32 v41, 16, v12
    v_and_b32 v42, 0xffff0000, v12
    v_fmac_f32 v44, v25, v41
    v_fmac_f32 v45, v25, v42
    v_fmac_f32 v52, v29, v41
    v_fmac_f32 v53, v29, v42
    v_lshlrev_b32 v41, 16, v13
    v_and_b32 v42, 0xffff0000, v13
    v_fmac_f32 v46, v25, v41
    v_fmac_f32 v47, v25, v42
    v_fmac_f32 v54, v29, v41
    v_fmac_f32 v55, v29, v42
    v_lshlrev_b32 v41, 16, v14
    v_and_b32 v42, 0xffff0000, v14
    v_fmac_f32 v48, v25, v41
    v_fmac_f32 v49, v25, v42
    v_fmac_f32 v56, v29, v41
    v_fmac_f32 v57, v29, v42
    v_lshlrev_b32 v41, 16, v15
    v_and_b32 v42, 0xffff0000, v15
    v_fmac_f32 v50, v25, v41
    v_fmac_f32 v51, v25, v42
    v_fmac_f32 v58, v29, v41
    v_fmac_f32 v59, v29, v42
    v_lshlrev_b32 v41, 16, v16
    v_and_b32 v42, 0xffff0000, v16
    v_fmac_f32 v44, v26, v41
    v_fmac_f32 v45, v26, v42
    v_fmac_f32 v52, v30, v41
    v_fmac_f32 v53, v30, v42
    v_lshlrev_b32 v41, 16, v17
    v_and_b32 v42, 0xffff0000, v17
    v_fmac_f32 v46, v26, v41
    v_fmac_f32 v47, v26, v42
    v_fmac_f32 v54, v30, v41
    v_fmac_f32 v55, v30, v42
    v_lshlrev_b32 v41, 16, v18
    v_and_b32 v42, 0xffff0000, v18
    v_fmac_f32 v48, v26, v41
    v_fmac_f32 v49, v26, v42
    v_fmac_f32 v56, v30, v41
    v_fmac_f32 v57, v30, v42
    v_lshlrev_b32 v41, 16, v19
    v_and_b32 v42, 0xffff0000, v19
    v_fmac_f32 v50, v26, v41
    v_fmac_f32 v51, v26, v42
    v_fmac_f32 v58, v30, v41
    v_fmac_f32 v59, v30, v42
    v_lshlrev_b32 v41, 16, v20
    v_and_b32 v42, 0xffff0000, v20
    v_fmac_f32 v44, v27, v41
    v_fmac_f32 v45, v27, v42
    v_fmac_f32 v52, v31, v41
    v_fmac_f32 v53, v31, v42
    v_lshlrev_b32 v41, 16, v21
    v_and_b32 v42, 0xffff0000, v21
    v_fmac_f32 v46, v27, v41
    v_fmac_f32 v47, v27, v42
    v_fmac_f32 v54, v31, v41
    v_fmac_f32 v55, v31, v42
    v_lshlrev_b32 v41, 16, v22
    v_and_b32 v42, 0xffff0000, v22
    v_fmac_f32 v48, v27, v41
    v_fmac_f32 v49, v27, v42
    v_fmac_f32 v56, v31, v41
    v_fmac_f32 v57, v31, v42
    v_lshlrev_b32 v41, 16, v23
    v_and_b32 v42, 0xffff0000, v23
    v_fmac_f32 v50, v27, v41
    v_fmac_f32 v51, v27, v42
    v_fmac_f32 v58, v31, v41
    v_fmac_f32 v59, v31, v42
    v_lshlrev_b32 v60, 6, v0
    v_add_u32 v60, 0, v60
    ds_write_b128 v60, v[44:47] offset:0
    ds_write_b128 v60, v[48:51] offset:16
    ds_write_b128 v60, v[52:55] offset:32
    ds_write_b128 v60, v[56:59] offset:48
    s_waitcnt lgkmcnt(0)
    s_barrier
    v_lshlrev_b32 v60, 2, v0
    v_add_u32 v60, 0, v60
    ds_read_b32 v64, v60 offset:0
    ds_read_b32 v65, v60 offset:512
    ds_read_b32 v66, v60 offset:1024
    ds_read_b32 v67, v60 offset:1536
    ds_read_b32 v68, v60 offset:2048
    ds_read_b32 v69, v60 offset:2560
    ds_read_b32 v70, v60 offset:3072
    ds_read_b32 v71, v60 offset:3584
    ds_read_b32 v72, v60 offset:4096
    ds_read_b32 v73, v60 offset:4608
    ds_read_b32 v74, v60 offset:5120
    ds_read_b32 v75, v60 offset:5632
    ds_read_b32 v76, v60 offset:6144
    ds_read_b32 v77, v60 offset:6656
    ds_read_b32 v78, v60 offset:7168
    ds_read_b32 v79, v60 offset:7680
    ds_read_b32 v80, v60 offset:8192
    ds_read_b32 v81, v60 offset:8704
    ds_read_b32 v82, v60 offset:9216
    ds_read_b32 v83, v60 offset:9728
    ds_read_b32 v84, v60 offset:10240
    ds_read_b32 v85, v60 offset:10752
    ds_read_b32 v86, v60 offset:11264
    ds_read_b32 v87, v60 offset:11776
    ds_read_b32 v88, v60 offset:12288
    ds_read_b32 v89, v60 offset:12800
    ds_read_b32 v90, v60 offset:13312
    ds_read_b32 v91, v60 offset:13824
    ds_read_b32 v92, v60 offset:14336
    ds_read_b32 v93, v60 offset:14848
    ds_read_b32 v94, v60 offset:15360
    ds_read_b32 v95, v60 offset:15872
    s_waitcnt lgkmcnt(0)
    v_add_f32 v40, v64, v65
    v_add_f32 v40, v40, v66
    v_add_f32 v40, v40, v67
    v_add_f32 v40, v40, v68
    v_add_f32 v40, v40, v69
    v_add_f32 v40, v40, v70
    v_add_f32 v40, v40, v71
    v_add_f32 v40, v40, v72
    v_add_f32 v40, v40, v73
    v_add_f32 v40, v40, v74
    v_add_f32 v40, v40, v75
    v_add_f32 v40, v40, v76
    v_add_f32 v40, v40, v77
    v_add_f32 v40, v40, v78
    v_add_f32 v40, v40, v79
    v_add_f32 v40, v40, v80
    v_add_f32 v40, v40, v81
    v_add_f32 v40, v40, v82
    v_add_f32 v40, v40, v83
    v_add_f32 v40, v40, v84
    v_add_f32 v40, v40, v85
    v_add_f32 v40, v40, v86
    v_add_f32 v40, v40, v87
    v_add_f32 v40, v40, v88
    v_add_f32 v40, v40, v89
    v_add_f32 v40, v40, v90
    v_add_f32 v40, v40, v91
    v_add_f32 v40, v40, v92
    v_add_f32 v40, v40, v93
    v_add_f32 v40, v40, v94
    v_add_f32 v40, v40, v95
    v_cmp_gt_u32 vcc, 128, v0
    v_lshrrev_b32 v1, 4, v0
    v_bfe_u32 v2, v0, 3, 1
    v_and_b32 v3, 7, v0
    s_mul_i32 s14, s10, 6144
    s_lshl_b32 s15, s11, 6
    s_add_u32 s14, s14, s15
    v_lshl_add_u32 v4, v1, 3, v3
    v_mul_u32_u24 v5, 3072, v2
    v_add3_u32 v4, v4, v5, s14
    v_lshlrev_b32 v4, 2, v4
    s_and_saveexec_b64 s[16:17], vcc
    s_cbranch_execz K1_END
    global_store_dword v4, v40, s[8:9] offset:0
K1_END:
    s_endpgm
.section .rodata,"a"
.p2align 6
.amdhsa_kernel k1_kernel
  .amdhsa_next_free_vgpr 96
  .amdhsa_next_free_sgpr 102
  .amdhsa_accum_offset 96
  .amdhsa_group_segment_fixed_size 0
  .amdhsa_kernarg_size 112
  .amdhsa_user_sgpr_count 2
  .amdhsa_user_sgpr_kernarg_segment_ptr 1
  .amdhsa_system_sgpr_workgroup_id_x 1
.end_amdhsa_kernel
.text
.globl k2_kernel
.p2align 8
.type k2_kernel,@function
k2_kernel:
    s_cmp_ge_u32 s2, 256
    s_cbranch_scc1 K2_END
    s_load_dwordx2 s[4:5], s[0:1], 0
    s_load_dwordx2 s[6:7], s[0:1], 24
    s_load_dwordx2 s[8:9], s[0:1], 104
    s_and_b32 s10, s2, 3
    s_lshr_b32 s11, s2, 2
    v_lshrrev_b32 v1, 3, v0
    v_and_b32 v2, 7, v0
    s_lshl_b32 s12, s10, 7
    v_lshl_add_u32 v3, v1, 2, s12
    v_lshlrev_b32 v4, 13, v3
    s_lshl_b32 s13, s11, 7
    v_lshl_add_u32 v5, v2, 4, s13
    v_add_u32 v4, v4, v5
    v_and_b32 v6, 63, v0
    v_lshlrev_b32 v6, 4, v6
    s_waitcnt lgkmcnt(0)
    global_load_dwordx4 v[8:11], v4, s[6:7]
    v_add_u32 v4, 0x2000, v4
    global_load_dwordx4 v[12:15], v4, s[6:7]
    v_add_u32 v4, 0x2000, v4
    global_load_dwordx4 v[16:19], v4, s[6:7]
    v_add_u32 v4, 0x2000, v4
    global_load_dwordx4 v[20:23], v4, s[6:7]
    global_load_dwordx4 v[24:27], v6, s[4:5]
    global_load_dwordx4 v[28:31], v6, s[4:5] offset:1024
    v_lshrrev_b32 v32, 7, v0
    v_and_b32 v33, 127, v0
    v_add_u32 v33, s12, v33
    v_mul_u32_u24 v34, 3072, v32
    v_add_u32 v34, v34, v33
    v_lshlrev_b32 v34, 2, v34
    v_add_u32 v35, 0, v34
    global_load_dword v36, v35, s[8:9]
    global_load_dword v40, v35, s[8:9] offset:2048
    v_add_u32 v35, 24576, v34
    global_load_dword v37, v35, s[8:9]
    global_load_dword v41, v35, s[8:9] offset:2048
    v_add_u32 v35, 49152, v34
    global_load_dword v38, v35, s[8:9]
    global_load_dword v42, v35, s[8:9] offset:2048
    v_add_u32 v35, 73728, v34
    global_load_dword v39, v35, s[8:9]
    global_load_dword v43, v35, s[8:9] offset:2048
    v_lshlrev_b32 v35, 1, v33
    v_lshl_add_u32 v35, v32, 10, v35
    global_load_ushort v44, v35, s[4:5]
    s_waitcnt vmcnt(9)
    v_lshlrev_b32 v48, 16, v24
    v_and_b32 v49, 0xffff0000, v24
    v_lshlrev_b32 v50, 16, v25
    v_and_b32 v51, 0xffff0000, v25
    v_lshlrev_b32 v52, 16, v26
    v_and_b32 v53, 0xffff0000, v26
    v_lshlrev_b32 v54, 16, v27
    v_and_b32 v55, 0xffff0000, v27
    v_lshlrev_b32 v56, 16, v28
    v_and_b32 v57, 0xffff0000, v28
    v_lshlrev_b32 v58, 16, v29
    v_and_b32 v59, 0xffff0000, v29
    v_lshlrev_b32 v60, 16, v30
    v_and_b32 v61, 0xffff0000, v30
    v_lshlrev_b32 v62, 16, v31
    v_and_b32 v63, 0xffff0000, v31
    v_add_f32 v64, v48, v49
    v_add_f32 v64, v64, v50
    v_add_f32 v64, v64, v51
    v_add_f32 v64, v64, v52
    v_add_f32 v64, v64, v53
    v_add_f32 v64, v64, v54
    v_add_f32 v64, v64, v55
    s_nop 1
    v_add_f32_dpp v64, v64, v64 quad_perm:[1,0,3,2] row_mask:0xf bank_mask:0xf
    s_nop 1
    v_add_f32_dpp v64, v64, v64 quad_perm:[2,3,0,1] row_mask:0xf bank_mask:0xf
    s_nop 1
    v_add_f32_dpp v64, v64, v64 row_half_mirror row_mask:0xf bank_mask:0xf
    s_nop 1
    v_add_f32_dpp v64, v64, v64 row_mirror row_mask:0xf bank_mask:0xf
    v_mov_b32 v65, v64
    s_nop 1
    v_permlane16_swap_b32 v65, v64
    s_nop 1
    v_add_f32 v64, v64, v65
    v_mov_b32 v65, v64
    s_nop 1
    v_permlane32_swap_b32 v65, v64
    s_nop 1
    v_add_f32 v64, v64, v65
    v_mul_f32 v64, 0x3b000000, v64
    v_sub_f32 v65, v48, v64
    v_mul_f32 v67, v65, v65
    v_sub_f32 v65, v49, v64
    v_fmac_f32 v67, v65, v65
    v_sub_f32 v65, v50, v64
    v_fmac_f32 v67, v65, v65
    v_sub_f32 v65, v51, v64
    v_fmac_f32 v67, v65, v65
    v_sub_f32 v65, v52, v64
    v_fmac_f32 v67, v65, v65
    v_sub_f32 v65, v53, v64
    v_fmac_f32 v67, v65, v65
    v_sub_f32 v65, v54, v64
    v_fmac_f32 v67, v65, v65
    v_sub_f32 v65, v55, v64
    v_fmac_f32 v67, v65, v65
    s_nop 1
    v_add_f32_dpp v67, v67, v67 quad_perm:[1,0,3,2] row_mask:0xf bank_mask:0xf
    s_nop 1
    v_add_f32_dpp v67, v67, v67 quad_perm:[2,3,0,1] row_mask:0xf bank_mask:0xf
    s_nop 1
    v_add_f32_dpp v67, v67, v67 row_half_mirror row_mask:0xf bank_mask:0xf
    s_nop 1
    v_add_f32_dpp v67, v67, v67 row_mirror row_mask:0xf bank_mask:0xf
    v_mov_b32 v65, v67
    s_nop 1
    v_permlane16_swap_b32 v65, v67
    s_nop 1
    v_add_f32 v67, v67, v65
    v_mov_b32 v65, v67
    s_nop 1
    v_permlane32_swap_b32 v65, v67
    s_nop 1
    v_add_f32 v67, v67, v65
    v_mul_f32 v67, 0x3b000000, v67
    v_cvt_pk_bf16_f32 v67, v67, v67
    v_and_b32 v67, 0xffff0000, v67
    v_add_f32 v67, 0x3727c5ac, v67
    v_cvt_pk_bf16_f32 v67, v67, v67
    v_and_b32 v67, 0xffff0000, v67
    v_sqrt_f32 v67, v67
    s_nop 0
    v_cvt_pk_bf16_f32 v67, v67, v67
    v_and_b32 v67, 0xffff0000, v67
    v_cvt_pk_bf16_f32 v66, v64, v64
    v_and_b32 v66, 0xffff0000, v66
    v_add_f32 v64, v56, v57
    v_add_f32 v64, v64, v58
    v_add_f32 v64, v64, v59
    v_add_f32 v64, v64, v60
    v_add_f32 v64, v64, v61
    v_add_f32 v64, v64, v62
    v_add_f32 v64, v64, v63
    s_nop 1
    v_add_f32_dpp v64, v64, v64 quad_perm:[1,0,3,2] row_mask:0xf bank_mask:0xf
    s_nop 1
    v_add_f32_dpp v64, v64, v64 quad_perm:[2,3,0,1] row_mask:0xf bank_mask:0xf
    s_nop 1
    v_add_f32_dpp v64, v64, v64 row_half_mirror row_mask:0xf bank_mask:0xf
    s_nop 1
    v_add_f32_dpp v64, v64, v64 row_mirror row_mask:0xf bank_mask:0xf
    v_mov_b32 v65, v64
    s_nop 1
    v_permlane16_swap_b32 v65, v64
    s_nop 1
    v_add_f32 v64, v64, v65
    v_mov_b32 v65, v64
    s_nop 1
    v_permlane32_swap_b32 v65, v64
    s_nop 1
    v_add_f32 v64, v64, v65
    v_mul_f32 v64, 0x3b000000, v64
    v_sub_f32 v65, v56, v64
    v_mul_f32 v69, v65, v65
    v_sub_f32 v65, v57, v64
    v_fmac_f32 v69, v65, v65
    v_sub_f32 v65, v58, v64
    v_fmac_f32 v69, v65, v65
    v_sub_f32 v65, v59, v64
    v_fmac_f32 v69, v65, v65
    v_sub_f32 v65, v60, v64
    v_fmac_f32 v69, v65, v65
    v_sub_f32 v65, v61, v64
    v_fmac_f32 v69, v65, v65
    v_sub_f32 v65, v62, v64
    v_fmac_f32 v69, v65, v65
    v_sub_f32 v65, v63, v64
    v_fmac_f32 v69, v65, v65
    s_nop 1
    v_add_f32_dpp v69, v69, v69 quad_perm:[1,0,3,2] row_mask:0xf bank_mask:0xf
    s_nop 1
    v_add_f32_dpp v69, v69, v69 quad_perm:[2,3,0,1] row_mask:0xf bank_mask:0xf
    s_nop 1
    v_add_f32_dpp v69, v69, v69 row_half_mirror row_mask:0xf bank_mask:0xf
    s_nop 1
    v_add_f32_dpp v69, v69, v69 row_mirror row_mask:0xf bank_mask:0xf
    v_mov_b32 v65, v69
    s_nop 1
    v_permlane16_swap_b32 v65, v69
    s_nop 1
    v_add_f32 v69, v69, v65
    v_mov_b32 v65, v69
    s_nop 1
    v_permlane32_swap_b32 v65, v69
    s_nop 1
    v_add_f32 v69, v69, v65
    v_mul_f32 v69, 0x3b000000, v69
    v_cvt_pk_bf16_f32 v69, v69, v69
    v_and_b32 v69, 0xffff0000, v69
    v_add_f32 v69, 0x3727c5ac, v69
    v_cvt_pk_bf16_f32 v69, v69, v69
    v_and_b32 v69, 0xffff0000, v69
    v_sqrt_f32 v69, v69
    s_nop 0
    v_cvt_pk_bf16_f32 v69, v69, v69
    v_and_b32 v69, 0xffff0000, v69
    v_cvt_pk_bf16_f32 v68, v64, v64
    v_and_b32 v68, 0xffff0000, v68
    s_waitcnt vmcnt(0)
    v_add_f32 v36, v36, v37
    v_add_f32 v38, v38, v39
    v_add_f32 v36, v36, v38
    v_add_f32 v40, v40, v41
    v_add_f32 v42, v42, v43
    v_add_f32 v40, v40, v42
    v_cvt_pk_bf16_f32 v36, v36, v36
    v_and_b32 v36, 0xffff0000, v36
    v_cvt_pk_bf16_f32 v40, v40, v40
    v_and_b32 v40, 0xffff0000, v40
    v_cmp_eq_u32 vcc, 0, v32
    s_nop 1
    v_cndmask_b32 v66, v68, v66, vcc
    v_cndmask_b32 v67, v69, v67, vcc
    v_lshlrev_b32 v44, 16, v44
    v_sub_f32 v44, v44, v66
    v_cvt_pk_bf16_f32 v44, v44, v44
    v_and_b32 v44, 0xffff0000, v44
    v_rcp_f32 v67, v67
    s_nop 0
    v_mul_f32 v44, v44, v67
    v_cvt_pk_bf16_f32 v44, v44, v44
    v_and_b32 v44, 0xffff0000, v44
    v_add_f32 v40, 1.0, v40
    v_cvt_pk_bf16_f32 v40, v40, v40
    v_and_b32 v40, 0xffff0000, v40
    v_mul_f32 v44, v44, v40
    v_cvt_pk_bf16_f32 v44, v44, v44
    v_and_b32 v44, 0xffff0000, v44
    v_add_f32 v44, v44, v36
    v_cvt_pk_bf16_f32 v44, v44, v44
    v_and_b32 v44, 0xffff0000, v44
    v_lshlrev_b32 v45, 2, v0
    ds_write_b32 v45, v44 offset:16384
    s_waitcnt lgkmcnt(0)
    s_barrier
    v_lshlrev_b32 v45, 4, v1
    ds_read_b128 v[24:27], v45 offset:16384
    ds_read_b128 v[28:31], v45 offset:16896
    s_waitcnt lgkmcnt(0)
    v_mov_b32 v44, 0
    v_mov_b32 v45, 0
    v_mov_b32 v46, 0
    v_mov_b32 v47, 0
    v_mov_b32 v48, 0
    v_mov_b32 v49, 0
    v_mov_b32 v50, 0
    v_mov_b32 v51, 0
    v_mov_b32 v52, 0
    v_mov_b32 v53, 0
    v_mov_b32 v54, 0
    v_mov_b32 v55, 0
    v_mov_b32 v56, 0
    v_mov_b32 v57, 0
    v_mov_b32 v58, 0
    v_mov_b32 v59, 0
    v_lshlrev_b32 v41, 16, v8
    v_and_b32 v42, 0xffff0000, v8
    v_fmac_f32 v44, v24, v41
    v_fmac_f32 v45, v24, v42
    v_fmac_f32 v52, v28, v41
    v_fmac_f32 v53, v28, v42
    v_lshlrev_b32 v41, 16, v9
    v_and_b32 v42, 0xffff0000, v9
    v_fmac_f32 v46, v24, v41
    v_fmac_f32 v47, v24, v42
    v_fmac_f32 v54, v28, v41
    v_fmac_f32 v55, v28, v42
    v_lshlrev_b32 v41, 16, v10
    v_and_b32 v42, 0xffff0000, v10
    v_fmac_f32 v48, v24, v41
    v_fmac_f32 v49, v24, v42
    v_fmac_f32 v56, v28, v41
    v_fmac_f32 v57, v28, v42
    v_lshlrev_b32 v41, 16, v11
    v_and_b32 v42, 0xffff0000, v11
    v_fmac_f32 v50, v24, v41
    v_fmac_f32 v51, v24, v42
    v_fmac_f32 v58, v28, v41
    v_fmac_f32 v59, v28, v42
    v_lshlrev_b32 v41, 16, v12
    v_and_b32 v42, 0xffff0000, v12
    v_fmac_f32 v44, v25, v41
    v_fmac_f32 v45, v25, v42
    v_fmac_f32 v52, v29, v41
    v_fmac_f32 v53, v29, v42
    v_lshlrev_b32 v41, 16, v13
    v_and_b32 v42, 0xffff0000, v13
    v_fmac_f32 v46, v25, v41
    v_fmac_f32 v47, v25, v42
    v_fmac_f32 v54, v29, v41
    v_fmac_f32 v55, v29, v42
    v_lshlrev_b32 v41, 16, v14
    v_and_b32 v42, 0xffff0000, v14
    v_fmac_f32 v48, v25, v41
    v_fmac_f32 v49, v25, v42
    v_fmac_f32 v56, v29, v41
    v_fmac_f32 v57, v29, v42
    v_lshlrev_b32 v41, 16, v15
    v_and_b32 v42, 0xffff0000, v15
    v_fmac_f32 v50, v25, v41
    v_fmac_f32 v51, v25, v42
    v_fmac_f32 v58, v29, v41
    v_fmac_f32 v59, v29, v42
    v_lshlrev_b32 v41, 16, v16
    v_and_b32 v42, 0xffff0000, v16
    v_fmac_f32 v44, v26, v41
    v_fmac_f32 v45, v26, v42
    v_fmac_f32 v52, v30, v41
    v_fmac_f32 v53, v30, v42
    v_lshlrev_b32 v41, 16, v17
    v_and_b32 v42, 0xffff0000, v17
    v_fmac_f32 v46, v26, v41
    v_fmac_f32 v47, v26, v42
    v_fmac_f32 v54, v30, v41
    v_fmac_f32 v55, v30, v42
    v_lshlrev_b32 v41, 16, v18
    v_and_b32 v42, 0xffff0000, v18
    v_fmac_f32 v48, v26, v41
    v_fmac_f32 v49, v26, v42
    v_fmac_f32 v56, v30, v41
    v_fmac_f32 v57, v30, v42
    v_lshlrev_b32 v41, 16, v19
    v_and_b32 v42, 0xffff0000, v19
    v_fmac_f32 v50, v26, v41
    v_fmac_f32 v51, v26, v42
    v_fmac_f32 v58, v30, v41
    v_fmac_f32 v59, v30, v42
    v_lshlrev_b32 v41, 16, v20
    v_and_b32 v42, 0xffff0000, v20
    v_fmac_f32 v44, v27, v41
    v_fmac_f32 v45, v27, v42
    v_fmac_f32 v52, v31, v41
    v_fmac_f32 v53, v31, v42
    v_lshlrev_b32 v41, 16, v21
    v_and_b32 v42, 0xffff0000, v21
    v_fmac_f32 v46, v27, v41
    v_fmac_f32 v47, v27, v42
    v_fmac_f32 v54, v31, v41
    v_fmac_f32 v55, v31, v42
    v_lshlrev_b32 v41, 16, v22
    v_and_b32 v42, 0xffff0000, v22
    v_fmac_f32 v48, v27, v41
    v_fmac_f32 v49, v27, v42
    v_fmac_f32 v56, v31, v41
    v_fmac_f32 v57, v31, v42
    v_lshlrev_b32 v41, 16, v23
    v_and_b32 v42, 0xffff0000, v23
    v_fmac_f32 v50, v27, v41
    v_fmac_f32 v51, v27, v42
    v_fmac_f32 v58, v31, v41
    v_fmac_f32 v59, v31, v42
    v_lshlrev_b32 v60, 6, v0
    v_add_u32 v60, 0, v60
    ds_write_b128 v60, v[44:47] offset:0
    ds_write_b128 v60, v[48:51] offset:16
    ds_write_b128 v60, v[52:55] offset:32
    ds_write_b128 v60, v[56:59] offset:48
    s_waitcnt lgkmcnt(0)
    s_barrier
    v_lshlrev_b32 v60, 2, v0
    v_add_u32 v60, 0, v60
    ds_read_b32 v64, v60 offset:0
    ds_read_b32 v65, v60 offset:512
    ds_read_b32 v66, v60 offset:1024
    ds_read_b32 v67, v60 offset:1536
    ds_read_b32 v68, v60 offset:2048
    ds_read_b32 v69, v60 offset:2560
    ds_read_b32 v70, v60 offset:3072
    ds_read_b32 v71, v60 offset:3584
    ds_read_b32 v72, v60 offset:4096
    ds_read_b32 v73, v60 offset:4608
    ds_read_b32 v74, v60 offset:5120
    ds_read_b32 v75, v60 offset:5632
    ds_read_b32 v76, v60 offset:6144
    ds_read_b32 v77, v60 offset:6656
    ds_read_b32 v78, v60 offset:7168
    ds_read_b32 v79, v60 offset:7680
    ds_read_b32 v80, v60 offset:8192
    ds_read_b32 v81, v60 offset:8704
    ds_read_b32 v82, v60 offset:9216
    ds_read_b32 v83, v60 offset:9728
    ds_read_b32 v84, v60 offset:10240
    ds_read_b32 v85, v60 offset:10752
    ds_read_b32 v86, v60 offset:11264
    ds_read_b32 v87, v60 offset:11776
    ds_read_b32 v88, v60 offset:12288
    ds_read_b32 v89, v60 offset:12800
    ds_read_b32 v90, v60 offset:13312
    ds_read_b32 v91, v60 offset:13824
    ds_read_b32 v92, v60 offset:14336
    ds_read_b32 v93, v60 offset:14848
    ds_read_b32 v94, v60 offset:15360
    ds_read_b32 v95, v60 offset:15872
    s_waitcnt lgkmcnt(0)
    v_add_f32 v40, v64, v65
    v_add_f32 v40, v40, v66
    v_add_f32 v40, v40, v67
    v_add_f32 v40, v40, v68
    v_add_f32 v40, v40, v69
    v_add_f32 v40, v40, v70
    v_add_f32 v40, v40, v71
    v_add_f32 v40, v40, v72
    v_add_f32 v40, v40, v73
    v_add_f32 v40, v40, v74
    v_add_f32 v40, v40, v75
    v_add_f32 v40, v40, v76
    v_add_f32 v40, v40, v77
    v_add_f32 v40, v40, v78
    v_add_f32 v40, v40, v79
    v_add_f32 v40, v40, v80
    v_add_f32 v40, v40, v81
    v_add_f32 v40, v40, v82
    v_add_f32 v40, v40, v83
    v_add_f32 v40, v40, v84
    v_add_f32 v40, v40, v85
    v_add_f32 v40, v40, v86
    v_add_f32 v40, v40, v87
    v_add_f32 v40, v40, v88
    v_add_f32 v40, v40, v89
    v_add_f32 v40, v40, v90
    v_add_f32 v40, v40, v91
    v_add_f32 v40, v40, v92
    v_add_f32 v40, v40, v93
    v_add_f32 v40, v40, v94
    v_add_f32 v40, v40, v95
    v_cmp_gt_u32 vcc, 128, v0
    v_lshrrev_b32 v1, 4, v0
    v_bfe_u32 v2, v0, 3, 1
    v_and_b32 v3, 7, v0
    s_lshl_b32 s14, s10, 13
    s_lshl_b32 s15, s11, 6
    s_add_u32 s14, s14, s15
    v_lshl_add_u32 v4, v1, 3, v3
    v_lshlrev_b32 v5, 12, v2
    v_add3_u32 v4, v4, v5, s14
    v_lshlrev_b32 v4, 2, v4
    v_add_u32 v4, 131072, v4
    s_and_saveexec_b64 s[16:17], vcc
    s_cbranch_execz K2_END
    global_store_dword v4, v40, s[8:9]
K2_END:
    s_endpgm
.section .rodata,"a"
.p2align 6
.amdhsa_kernel k2_kernel
  .amdhsa_next_free_vgpr 96
  .amdhsa_next_free_sgpr 102
  .amdhsa_accum_offset 96
  .amdhsa_group_segment_fixed_size 0
  .amdhsa_kernarg_size 112
  .amdhsa_user_sgpr_count 2
  .amdhsa_user_sgpr_kernarg_segment_ptr 1
  .amdhsa_system_sgpr_workgroup_id_x 1
.end_amdhsa_kernel
.text
.globl k3_kernel
.p2align 8
.type k3_kernel,@function
k3_kernel:
    s_cmp_ge_u32 s2, 256
    s_cbranch_scc1 K3_END
    s_load_dwordx2 s[4:5], s[0:1], 8
    s_load_dwordx2 s[8:9], s[0:1], 16
    s_load_dwordx2 s[12:13], s[0:1], 104
    s_lshr_b32 s14, s2, 4
    s_and_b32 s15, s2, 15
    v_lshrrev_b32 v1, 6, v0
    v_and_b32 v2, 63, v0
    v_and_b32 v3, 15, v2
    v_lshrrev_b32 v4, 4, v2
    s_waitcnt lgkmcnt(0)
    s_mov_b32 s6, 0x8000000
    s_mov_b32 s7, 0x00020000
    s_mov_b32 s10, 0x8000000
    s_mov_b32 s11, 0x00020000
    s_lshr_b32 s16, s14, 3
    s_and_b32 s17, s14, 7
    s_lshl_b32 s16, s16, 12
    s_lshl_b32 s17, s17, 9
    s_add_u32 s16, s16, s17
    v_add_u32 v5, s16, v0
    v_lshlrev_b32 v5, 2, v5
    v_add_u32 v5, 131072, v5
    global_load_dword v8, v5, s[12:13]
    v_add_u32 v5, 0x8000, v5
    global_load_dword v9, v5, s[12:13]
    v_add_u32 v5, 0x8000, v5
    global_load_dword v10, v5, s[12:13]
    v_add_u32 v5, 0x8000, v5
    global_load_dword v11, v5, s[12:13]
    s_cmp_ge_u32 s2, 12
    s_cbranch_scc1 K3_NOMOD
    s_lshl_b32 s24, s2, 9
    v_add_u32 v12, s24, v0
    v_lshlrev_b32 v12, 2, v12
    global_load_dword v13, v12, s[12:13]
    v_add_u32 v17, 24576, v12
    global_load_dword v14, v17, s[12:13]
    v_add_u32 v17, 49152, v12
    global_load_dword v15, v17, s[12:13]
    v_add_u32 v17, 73728, v12
    global_load_dword v16, v17, s[12:13]
    s_waitcnt vmcnt(0)
    v_add_f32 v13, v13, v14
    v_add_f32 v15, v15, v16
    v_add_f32 v13, v13, v15
    v_cvt_pk_bf16_f32 v13, v13, v13
    v_and_b32 v13, 0xffff0000, v13
    v_add_u32 v12, 884736, v12
    global_store_dword v12, v13, s[12:13]
K3_NOMOD:
    s_lshl_b32 s18, s14, 23
    s_lshl_b32 s19, s15, 19
    s_add_u32 s18, s18, s19
    v_readfirstlane_b32 s19, v1
    s_nop 3
    s_lshl_b32 s19, s19, 16
    s_add_u32 s18, s18, s19
    v_lshlrev_b32 v6, 8, v3
    v_lshl_add_u32 v6, v4, 4, v6
    v_lshlrev_b32 v7, 10, v4
    v_lshl_add_u32 v7, v3, 4, v7
    s_nop 1
    s_add_u32 s20, s18, 0
    buffer_load_dwordx4 v[64:67], v6, s[4:7], s20 offen offset:0 nt
    buffer_load_dwordx4 v[68:71], v6, s[4:7], s20 offen offset:64 nt
    buffer_load_dwordx4 v[72:75], v6, s[4:7], s20 offen offset:128 nt
    buffer_load_dwordx4 v[76:79], v6, s[4:7], s20 offen offset:192 nt
    s_add_u32 s20, s18, 4096
    buffer_load_dwordx4 v[80:83], v6, s[4:7], s20 offen offset:0 nt
    buffer_load_dwordx4 v[84:87], v6, s[4:7], s20 offen offset:64 nt
    buffer_load_dwordx4 v[88:91], v6, s[4:7], s20 offen offset:128 nt
    buffer_load_dwordx4 v[92:95], v6, s[4:7], s20 offen offset:192 nt
    s_add_u32 s20, s18, 8192
    buffer_load_dwordx4 v[96:99], v6, s[4:7], s20 offen offset:0 nt
    buffer_load_dwordx4 v[100:103], v6, s[4:7], s20 offen offset:64 nt
    buffer_load_dwordx4 v[104:107], v6, s[4:7], s20 offen offset:128 nt
    buffer_load_dwordx4 v[108:111], v6, s[4:7], s20 offen offset:192 nt
    s_add_u32 s20, s18, 12288
    buffer_load_dwordx4 v[112:115], v6, s[4:7], s20 offen offset:0 nt
    buffer_load_dwordx4 v[116:119], v6, s[4:7], s20 offen offset:64 nt
    buffer_load_dwordx4 v[120:123], v6, s[4:7], s20 offen offset:128 nt
    buffer_load_dwordx4 v[124:127], v6, s[4:7], s20 offen offset:192 nt
    s_add_u32 s20, s18, 0
    buffer_load_dwordx4 v[128:131], v7, s[8:11], s20 offen offset:0 nt
    buffer_load_dwordx4 v[132:135], v7, s[8:11], s20 offen offset:256 nt
    buffer_load_dwordx4 v[136:139], v7, s[8:11], s20 offen offset:512 nt
    buffer_load_dwordx4 v[140:143], v7, s[8:11], s20 offen offset:768 nt
    s_add_u32 s20, s18, 4096
    buffer_load_dwordx4 v[144:147], v7, s[8:11], s20 offen offset:0 nt
    buffer_load_dwordx4 v[148:151], v7, s[8:11], s20 offen offset:256 nt
    buffer_load_dwordx4 v[152:155], v7, s[8:11], s20 offen offset:512 nt
    buffer_load_dwordx4 v[156:159], v7, s[8:11], s20 offen offset:768 nt
    s_add_u32 s20, s18, 8192
    buffer_load_dwordx4 v[160:163], v7, s[8:11], s20 offen offset:0 nt
    buffer_load_dwordx4 v[164:167], v7, s[8:11], s20 offen offset:256 nt
    buffer_load_dwordx4 v[168:171], v7, s[8:11], s20 offen offset:512 nt
    buffer_load_dwordx4 v[172:175], v7, s[8:11], s20 offen offset:768 nt
    s_add_u32 s20, s18, 12288
    buffer_load_dwordx4 v[176:179], v7, s[8:11], s20 offen offset:0 nt
    buffer_load_dwordx4 v[180:183], v7, s[8:11], s20 offen offset:256 nt
    buffer_load_dwordx4 v[184:187], v7, s[8:11], s20 offen offset:512 nt
    buffer_load_dwordx4 v[188:191], v7, s[8:11], s20 offen offset:768 nt
    s_waitcnt vmcnt(32)
    v_add_f32 v8, v8, v9
    v_add_f32 v10, v10, v11
    v_add_f32 v8, v8, v10
    v_cvt_pk_bf16_f32 v8, v8, v8
    v_lshlrev_b32 v5, 1, v0
    ds_write_b16 v5, v8
    v_lshrrev_b32 v9, 1, v3
    v_and_b32 v10, 1, v9
    v_lshrrev_b32 v9, 1, v9
    v_cmp_eq_u32 vcc, 1, v10
    v_mov_b32 v11, 0xffff
    v_mov_b32 v12, 0xffff0000
    s_nop 1
    v_cndmask_b32 v10, v11, v12, vcc
    v_cmp_eq_u32 vcc, 0, v9
    s_nop 1
    v_cndmask_b32 v232, 0, v10, vcc
    v_cmp_eq_u32 vcc, 1, v9
    s_nop 1
    v_cndmask_b32 v233, 0, v10, vcc
    v_cmp_eq_u32 vcc, 2, v9
    s_nop 1
    v_cndmask_b32 v234, 0, v10, vcc
    v_cmp_eq_u32 vcc, 3, v9
    s_nop 1
    v_cndmask_b32 v235, 0, v10, vcc
    v_mov_b32 v236, 0xff800000
    v_mov_b32 v237, 0xff800000
    v_mov_b32 v238, 0
    v_mov_b32 v239, 0
    v_mov_b32 v224, 0
    v_mov_b32 v225, 0
    v_mov_b32 v226, 0
    v_mov_b32 v227, 0
    v_mov_b32 v228, 0
    v_mov_b32 v229, 0
    v_mov_b32 v230, 0
    v_mov_b32 v231, 0
    s_waitcnt lgkmcnt(0)
    s_barrier
    v_and_b32 v9, 1, v3
    v_lshlrev_b32 v9, 8, v9
    v_lshl_add_u32 v9, v4, 4, v9
    ds_read_b128 v[16:19], v9 offset:0
    ds_read_b128 v[20:23], v9 offset:64
    ds_read_b128 v[24:27], v9 offset:128
    ds_read_b128 v[28:31], v9 offset:192
    ds_read_b128 v[32:35], v9 offset:512
    ds_read_b128 v[36:39], v9 offset:576
    ds_read_b128 v[40:43], v9 offset:640
    ds_read_b128 v[44:47], v9 offset:704
    s_waitcnt lgkmcnt(0)
    s_waitcnt vmcnt(16)
    v_mfma_f32_16x16x32_bf16 v[192:195], v[64:67], v[16:19], 0
    v_mfma_f32_16x16x32_bf16 v[192:195], v[68:71], v[20:23], v[192:195]
    v_mfma_f32_16x16x32_bf16 v[192:195], v[72:75], v[24:27], v[192:195]
    v_mfma_f32_16x16x32_bf16 v[192:195], v[76:79], v[28:31], v[192:195]
    v_mfma_f32_16x16x32_bf16 v[196:199], v[64:67], v[32:35], 0
    v_mfma_f32_16x16x32_bf16 v[196:199], v[68:71], v[36:39], v[196:199]
    v_mfma_f32_16x16x32_bf16 v[196:199], v[72:75], v[40:43], v[196:199]
    v_mfma_f32_16x16x32_bf16 v[196:199], v[76:79], v[44:47], v[196:199]
    v_mfma_f32_16x16x32_bf16 v[200:203], v[80:83], v[16:19], 0
    v_mfma_f32_16x16x32_bf16 v[200:203], v[84:87], v[20:23], v[200:203]
    v_mfma_f32_16x16x32_bf16 v[200:203], v[88:91], v[24:27], v[200:203]
    v_mfma_f32_16x16x32_bf16 v[200:203], v[92:95], v[28:31], v[200:203]
    v_mfma_f32_16x16x32_bf16 v[204:207], v[80:83], v[32:35], 0
    v_mfma_f32_16x16x32_bf16 v[204:207], v[84:87], v[36:39], v[204:207]
    v_mfma_f32_16x16x32_bf16 v[204:207], v[88:91], v[40:43], v[204:207]
    v_mfma_f32_16x16x32_bf16 v[204:207], v[92:95], v[44:47], v[204:207]
    v_mfma_f32_16x16x32_bf16 v[208:211], v[96:99], v[16:19], 0
    v_mfma_f32_16x16x32_bf16 v[208:211], v[100:103], v[20:23], v[208:211]
    v_mfma_f32_16x16x32_bf16 v[208:211], v[104:107], v[24:27], v[208:211]
    v_mfma_f32_16x16x32_bf16 v[208:211], v[108:111], v[28:31], v[208:211]
    v_mfma_f32_16x16x32_bf16 v[212:215], v[96:99], v[32:35], 0
    v_mfma_f32_16x16x32_bf16 v[212:215], v[100:103], v[36:39], v[212:215]
    v_mfma_f32_16x16x32_bf16 v[212:215], v[104:107], v[40:43], v[212:215]
    v_mfma_f32_16x16x32_bf16 v[212:215], v[108:111], v[44:47], v[212:215]
    v_mfma_f32_16x16x32_bf16 v[216:219], v[112:115], v[16:19], 0
    v_mfma_f32_16x16x32_bf16 v[216:219], v[116:119], v[20:23], v[216:219]
    v_mfma_f32_16x16x32_bf16 v[216:219], v[120:123], v[24:27], v[216:219]
    v_mfma_f32_16x16x32_bf16 v[216:219], v[124:127], v[28:31], v[216:219]
    v_mfma_f32_16x16x32_bf16 v[220:223], v[112:115], v[32:35], 0
    v_mfma_f32_16x16x32_bf16 v[220:223], v[116:119], v[36:39], v[220:223]
    v_mfma_f32_16x16x32_bf16 v[220:223], v[120:123], v[40:43], v[220:223]
    v_mfma_f32_16x16x32_bf16 v[220:223], v[124:127], v[44:47], v[220:223]
    s_add_u32 s20, s18, 16384
    buffer_load_dwordx4 v[64:67], v6, s[4:7], s20 offen offset:0 nt
    buffer_load_dwordx4 v[68:71], v6, s[4:7], s20 offen offset:64 nt
    buffer_load_dwordx4 v[72:75], v6, s[4:7], s20 offen offset:128 nt
    buffer_load_dwordx4 v[76:79], v6, s[4:7], s20 offen offset:192 nt
    s_add_u32 s20, s18, 20480
    buffer_load_dwordx4 v[80:83], v6, s[4:7], s20 offen offset:0 nt
    buffer_load_dwordx4 v[84:87], v6, s[4:7], s20 offen offset:64 nt
    buffer_load_dwordx4 v[88:91], v6, s[4:7], s20 offen offset:128 nt
    buffer_load_dwordx4 v[92:95], v6, s[4:7], s20 offen offset:192 nt
    s_add_u32 s20, s18, 24576
    buffer_load_dwordx4 v[96:99], v6, s[4:7], s20 offen offset:0 nt
    buffer_load_dwordx4 v[100:103], v6, s[4:7], s20 offen offset:64 nt
    buffer_load_dwordx4 v[104:107], v6, s[4:7], s20 offen offset:128 nt
    buffer_load_dwordx4 v[108:111], v6, s[4:7], s20 offen offset:192 nt
    s_add_u32 s20, s18, 28672
    buffer_load_dwordx4 v[112:115], v6, s[4:7], s20 offen offset:0 nt
    buffer_load_dwordx4 v[116:119], v6, s[4:7], s20 offen offset:64 nt
    buffer_load_dwordx4 v[120:123], v6, s[4:7], s20 offen offset:128 nt
    buffer_load_dwordx4 v[124:127], v6, s[4:7], s20 offen offset:192 nt
    s_nop 7
    s_nop 1
    v_max3_f32 v240, v192, v193, v194
    v_max3_f32 v240, v240, v195, v200
    v_max3_f32 v240, v240, v201, v202
    v_max3_f32 v240, v240, v203, v208
    v_max3_f32 v240, v240, v209, v210
    v_max3_f32 v240, v240, v211, v216
    v_max3_f32 v240, v240, v217, v218
    v_max3_f32 v240, v240, v219, v236
    v_mov_b32 v242, v240
    s_nop 1
    v_permlane16_swap_b32 v242, v240
    s_nop 1
    v_max_f32 v240, v240, v242
    v_mov_b32 v242, v240
    s_nop 1
    v_permlane32_swap_b32 v242, v240
    s_nop 1
    v_max_f32 v240, v240, v242
    v_sub_f32 v243, v236, v240
    v_mul_f32 v243, 0x3e0293ee, v243
    v_exp_f32 v244, v243
    v_mov_b32 v236, v240
    v_mul_f32 v243, 0x3e0293ee, v240
    s_mov_b32 s21, 0x3e0293ee
    v_fma_f32 v192, v192, s21, -v243
    v_fma_f32 v193, v193, s21, -v243
    v_fma_f32 v194, v194, s21, -v243
    v_fma_f32 v195, v195, s21, -v243
    v_fma_f32 v200, v200, s21, -v243
    v_fma_f32 v201, v201, s21, -v243
    v_fma_f32 v202, v202, s21, -v243
    v_fma_f32 v203, v203, s21, -v243
    v_fma_f32 v208, v208, s21, -v243
    v_fma_f32 v209, v209, s21, -v243
    v_fma_f32 v210, v210, s21, -v243
    v_fma_f32 v211, v211, s21, -v243
    v_fma_f32 v216, v216, s21, -v243
    v_fma_f32 v217, v217, s21, -v243
    v_fma_f32 v218, v218, s21, -v243
    v_fma_f32 v219, v219, s21, -v243
    v_exp_f32 v192, v192
    v_exp_f32 v193, v193
    v_exp_f32 v194, v194
    v_exp_f32 v195, v195
    v_exp_f32 v200, v200
    v_exp_f32 v201, v201
    v_exp_f32 v202, v202
    v_exp_f32 v203, v203
    v_exp_f32 v208, v208
    v_exp_f32 v209, v209
    v_exp_f32 v210, v210
    v_exp_f32 v211, v211
    v_exp_f32 v216, v216
    v_exp_f32 v217, v217
    v_exp_f32 v218, v218
    v_exp_f32 v219, v219
    s_nop 0
    v_mul_f32 v238, v238, v244
    v_add_f32 v238, v238, v192
    v_add_f32 v238, v238, v193
    v_add_f32 v238, v238, v194
    v_add_f32 v238, v238, v195
    v_add_f32 v238, v238, v200
    v_add_f32 v238, v238, v201
    v_add_f32 v238, v238, v202
    v_add_f32 v238, v238, v203
    v_add_f32 v238, v238, v208
    v_add_f32 v238, v238, v209
    v_add_f32 v238, v238, v210
    v_add_f32 v238, v238, v211
    v_add_f32 v238, v238, v216
    v_add_f32 v238, v238, v217
    v_add_f32 v238, v238, v218
    v_add_f32 v238, v238, v219
    v_max3_f32 v241, v196, v197, v198
    v_max3_f32 v241, v241, v199, v204
    v_max3_f32 v241, v241, v205, v206
    v_max3_f32 v241, v241, v207, v212
    v_max3_f32 v241, v241, v213, v214
    v_max3_f32 v241, v241, v215, v220
    v_max3_f32 v241, v241, v221, v222
    v_max3_f32 v241, v241, v223, v237
    v_mov_b32 v242, v241
    s_nop 1
    v_permlane16_swap_b32 v242, v241
    s_nop 1
    v_max_f32 v241, v241, v242
    v_mov_b32 v242, v241
    s_nop 1
    v_permlane32_swap_b32 v242, v241
    s_nop 1
    v_max_f32 v241, v241, v242
    v_sub_f32 v243, v237, v241
    v_mul_f32 v243, 0x3e0293ee, v243
    v_exp_f32 v245, v243
    v_mov_b32 v237, v241
    v_mul_f32 v243, 0x3e0293ee, v241
    s_mov_b32 s21, 0x3e0293ee
    v_fma_f32 v196, v196, s21, -v243
    v_fma_f32 v197, v197, s21, -v243
    v_fma_f32 v198, v198, s21, -v243
    v_fma_f32 v199, v199, s21, -v243
    v_fma_f32 v204, v204, s21, -v243
    v_fma_f32 v205, v205, s21, -v243
    v_fma_f32 v206, v206, s21, -v243
    v_fma_f32 v207, v207, s21, -v243
    v_fma_f32 v212, v212, s21, -v243
    v_fma_f32 v213, v213, s21, -v243
    v_fma_f32 v214, v214, s21, -v243
    v_fma_f32 v215, v215, s21, -v243
    v_fma_f32 v220, v220, s21, -v243
    v_fma_f32 v221, v221, s21, -v243
    v_fma_f32 v222, v222, s21, -v243
    v_fma_f32 v223, v223, s21, -v243
    v_exp_f32 v196, v196
    v_exp_f32 v197, v197
    v_exp_f32 v198, v198
    v_exp_f32 v199, v199
    v_exp_f32 v204, v204
    v_exp_f32 v205, v205
    v_exp_f32 v206, v206
    v_exp_f32 v207, v207
    v_exp_f32 v212, v212
    v_exp_f32 v213, v213
    v_exp_f32 v214, v214
    v_exp_f32 v215, v215
    v_exp_f32 v220, v220
    v_exp_f32 v221, v221
    v_exp_f32 v222, v222
    v_exp_f32 v223, v223
    s_nop 0
    v_mul_f32 v239, v239, v245
    v_add_f32 v239, v239, v196
    v_add_f32 v239, v239, v197
    v_add_f32 v239, v239, v198
    v_add_f32 v239, v239, v199
    v_add_f32 v239, v239, v204
    v_add_f32 v239, v239, v205
    v_add_f32 v239, v239, v206
    v_add_f32 v239, v239, v207
    v_add_f32 v239, v239, v212
    v_add_f32 v239, v239, v213
    v_add_f32 v239, v239, v214
    v_add_f32 v239, v239, v215
    v_add_f32 v239, v239, v220
    v_add_f32 v239, v239, v221
    v_add_f32 v239, v239, v222
    v_add_f32 v239, v239, v223
    s_nop 1
    v_mul_f32_dpp v224, v244, v224 quad_perm:[0,0,2,2] row_mask:0xf bank_mask:0xf
    v_mul_f32_dpp v225, v244, v225 quad_perm:[1,1,3,3] row_mask:0xf bank_mask:0xf
    v_mul_f32_dpp v226, v244, v226 quad_perm:[0,0,2,2] row_mask:0xf bank_mask:0xf
    v_mul_f32_dpp v227, v244, v227 quad_perm:[1,1,3,3] row_mask:0xf bank_mask:0xf
    v_mul_f32_dpp v228, v245, v228 quad_perm:[0,0,2,2] row_mask:0xf bank_mask:0xf
    v_mul_f32_dpp v229, v245, v229 quad_perm:[1,1,3,3] row_mask:0xf bank_mask:0xf
    v_mul_f32_dpp v230, v245, v230 quad_perm:[0,0,2,2] row_mask:0xf bank_mask:0xf
    v_mul_f32_dpp v231, v245, v231 quad_perm:[1,1,3,3] row_mask:0xf bank_mask:0xf
    s_waitcnt vmcnt(16)
    v_cvt_pk_bf16_f32 v252, v192, v192
    v_and_b32 v240, v252, v232
    v_and_b32 v241, v252, v233
    v_and_b32 v242, v252, v234
    v_and_b32 v243, v252, v235
    s_nop 1
    v_mfma_f32_16x16x32_bf16 v[224:227], v[240:243], v[128:131], v[224:227]
    v_cvt_pk_bf16_f32 v252, v196, v196
    v_and_b32 v244, v252, v232
    v_and_b32 v245, v252, v233
    v_and_b32 v246, v252, v234
    v_and_b32 v247, v252, v235
    s_nop 1
    v_mfma_f32_16x16x32_bf16 v[228:231], v[244:247], v[128:131], v[228:231]
    v_cvt_pk_bf16_f32 v252, v193, v193
    v_and_b32 v248, v252, v232
    v_and_b32 v249, v252, v233
    v_and_b32 v250, v252, v234
    v_and_b32 v251, v252, v235
    s_nop 1
    v_mfma_f32_16x16x32_bf16 v[224:227], v[248:251], v[132:135], v[224:227]
    v_cvt_pk_bf16_f32 v252, v197, v197
    v_and_b32 v240, v252, v232
    v_and_b32 v241, v252, v233
    v_and_b32 v242, v252, v234
    v_and_b32 v243, v252, v235
    s_nop 1
    v_mfma_f32_16x16x32_bf16 v[228:231], v[240:243], v[132:135], v[228:231]
    v_cvt_pk_bf16_f32 v252, v194, v194
    v_and_b32 v244, v252, v232
    v_and_b32 v245, v252, v233
    v_and_b32 v246, v252, v234
    v_and_b32 v247, v252, v235
    s_nop 1
    v_mfma_f32_16x16x32_bf16 v[224:227], v[244:247], v[136:139], v[224:227]
    v_cvt_pk_bf16_f32 v252, v198, v198
    v_and_b32 v248, v252, v232
    v_and_b32 v249, v252, v233
    v_and_b32 v250, v252, v234
    v_and_b32 v251, v252, v235
    s_nop 1
    v_mfma_f32_16x16x32_bf16 v[228:231], v[248:251], v[136:139], v[228:231]
    v_cvt_pk_bf16_f32 v252, v195, v195
    v_and_b32 v240, v252, v232
    v_and_b32 v241, v252, v233
    v_and_b32 v242, v252, v234
    v_and_b32 v243, v252, v235
    s_nop 1
    v_mfma_f32_16x16x32_bf16 v[224:227], v[240:243], v[140:143], v[224:227]
    v_cvt_pk_bf16_f32 v252, v199, v199
    v_and_b32 v244, v252, v232
    v_and_b32 v245, v252, v233
    v_and_b32 v246, v252, v234
    v_and_b32 v247, v252, v235
    s_nop 1
    v_mfma_f32_16x16x32_bf16 v[228:231], v[244:247], v[140:143], v[228:231]
    v_cvt_pk_bf16_f32 v252, v200, v200
    v_and_b32 v248, v252, v232
    v_and_b32 v249, v252, v233
    v_and_b32 v250, v252, v234
    v_and_b32 v251, v252, v235
    s_nop 1
    v_mfma_f32_16x16x32_bf16 v[224:227], v[248:251], v[144:147], v[224:227]
    v_cvt_pk_bf16_f32 v252, v204, v204
    v_and_b32 v240, v252, v232
    v_and_b32 v241, v252, v233
    v_and_b32 v242, v252, v234
    v_and_b32 v243, v252, v235
    s_nop 1
    v_mfma_f32_16x16x32_bf16 v[228:231], v[240:243], v[144:147], v[228:231]
    v_cvt_pk_bf16_f32 v252, v201, v201
    v_and_b32 v244, v252, v232
    v_and_b32 v245, v252, v233
    v_and_b32 v246, v252, v234
    v_and_b32 v247, v252, v235
    s_nop 1
    v_mfma_f32_16x16x32_bf16 v[224:227], v[244:247], v[148:151], v[224:227]
    v_cvt_pk_bf16_f32 v252, v205, v205
    v_and_b32 v248, v252, v232
    v_and_b32 v249, v252, v233
    v_and_b32 v250, v252, v234
    v_and_b32 v251, v252, v235
    s_nop 1
    v_mfma_f32_16x16x32_bf16 v[228:231], v[248:251], v[148:151], v[228:231]
    v_cvt_pk_bf16_f32 v252, v202, v202
    v_and_b32 v240, v252, v232
    v_and_b32 v241, v252, v233
    v_and_b32 v242, v252, v234
    v_and_b32 v243, v252, v235
    s_nop 1
    v_mfma_f32_16x16x32_bf16 v[224:227], v[240:243], v[152:155], v[224:227]
    v_cvt_pk_bf16_f32 v252, v206, v206
    v_and_b32 v244, v252, v232
    v_and_b32 v245, v252, v233
    v_and_b32 v246, v252, v234
    v_and_b32 v247, v252, v235
    s_nop 1
    v_mfma_f32_16x16x32_bf16 v[228:231], v[244:247], v[152:155], v[228:231]
    v_cvt_pk_bf16_f32 v252, v203, v203
    v_and_b32 v248, v252, v232
    v_and_b32 v249, v252, v233
    v_and_b32 v250, v252, v234
    v_and_b32 v251, v252, v235
    s_nop 1
    v_mfma_f32_16x16x32_bf16 v[224:227], v[248:251], v[156:159], v[224:227]
    v_cvt_pk_bf16_f32 v252, v207, v207
    v_and_b32 v240, v252, v232
    v_and_b32 v241, v252, v233
    v_and_b32 v242, v252, v234
    v_and_b32 v243, v252, v235
    s_nop 1
    v_mfma_f32_16x16x32_bf16 v[228:231], v[240:243], v[156:159], v[228:231]
    v_cvt_pk_bf16_f32 v252, v208, v208
    v_and_b32 v244, v252, v232
    v_and_b32 v245, v252, v233
    v_and_b32 v246, v252, v234
    v_and_b32 v247, v252, v235
    s_nop 1
    v_mfma_f32_16x16x32_bf16 v[224:227], v[244:247], v[160:163], v[224:227]
    v_cvt_pk_bf16_f32 v252, v212, v212
    v_and_b32 v248, v252, v232
    v_and_b32 v249, v252, v233
    v_and_b32 v250, v252, v234
    v_and_b32 v251, v252, v235
    s_nop 1
    v_mfma_f32_16x16x32_bf16 v[228:231], v[248:251], v[160:163], v[228:231]
    v_cvt_pk_bf16_f32 v252, v209, v209
    v_and_b32 v240, v252, v232
    v_and_b32 v241, v252, v233
    v_and_b32 v242, v252, v234
    v_and_b32 v243, v252, v235
    s_nop 1
    v_mfma_f32_16x16x32_bf16 v[224:227], v[240:243], v[164:167], v[224:227]
    v_cvt_pk_bf16_f32 v252, v213, v213
    v_and_b32 v244, v252, v232
    v_and_b32 v245, v252, v233
    v_and_b32 v246, v252, v234
    v_and_b32 v247, v252, v235
    s_nop 1
    v_mfma_f32_16x16x32_bf16 v[228:231], v[244:247], v[164:167], v[228:231]
    v_cvt_pk_bf16_f32 v252, v210, v210
    v_and_b32 v248, v252, v232
    v_and_b32 v249, v252, v233
    v_and_b32 v250, v252, v234
    v_and_b32 v251, v252, v235
    s_nop 1
    v_mfma_f32_16x16x32_bf16 v[224:227], v[248:251], v[168:171], v[224:227]
    v_cvt_pk_bf16_f32 v252, v214, v214
    v_and_b32 v240, v252, v232
    v_and_b32 v241, v252, v233
    v_and_b32 v242, v252, v234
    v_and_b32 v243, v252, v235
    s_nop 1
    v_mfma_f32_16x16x32_bf16 v[228:231], v[240:243], v[168:171], v[228:231]
    v_cvt_pk_bf16_f32 v252, v211, v211
    v_and_b32 v244, v252, v232
    v_and_b32 v245, v252, v233
    v_and_b32 v246, v252, v234
    v_and_b32 v247, v252, v235
    s_nop 1
    v_mfma_f32_16x16x32_bf16 v[224:227], v[244:247], v[172:175], v[224:227]
    v_cvt_pk_bf16_f32 v252, v215, v215
    v_and_b32 v248, v252, v232
    v_and_b32 v249, v252, v233
    v_and_b32 v250, v252, v234
    v_and_b32 v251, v252, v235
    s_nop 1
    v_mfma_f32_16x16x32_bf16 v[228:231], v[248:251], v[172:175], v[228:231]
    v_cvt_pk_bf16_f32 v252, v216, v216
    v_and_b32 v240, v252, v232
    v_and_b32 v241, v252, v233
    v_and_b32 v242, v252, v234
    v_and_b32 v243, v252, v235
    s_nop 1
    v_mfma_f32_16x16x32_bf16 v[224:227], v[240:243], v[176:179], v[224:227]
    v_cvt_pk_bf16_f32 v252, v220, v220
    v_and_b32 v244, v252, v232
    v_and_b32 v245, v252, v233
    v_and_b32 v246, v252, v234
    v_and_b32 v247, v252, v235
    s_nop 1
    v_mfma_f32_16x16x32_bf16 v[228:231], v[244:247], v[176:179], v[228:231]
    v_cvt_pk_bf16_f32 v252, v217, v217
    v_and_b32 v248, v252, v232
    v_and_b32 v249, v252, v233
    v_and_b32 v250, v252, v234
    v_and_b32 v251, v252, v235
    s_nop 1
    v_mfma_f32_16x16x32_bf16 v[224:227], v[248:251], v[180:183], v[224:227]
    v_cvt_pk_bf16_f32 v252, v221, v221
    v_and_b32 v240, v252, v232
    v_and_b32 v241, v252, v233
    v_and_b32 v242, v252, v234
    v_and_b32 v243, v252, v235
    s_nop 1
    v_mfma_f32_16x16x32_bf16 v[228:231], v[240:243], v[180:183], v[228:231]
    v_cvt_pk_bf16_f32 v252, v218, v218
    v_and_b32 v244, v252, v232
    v_and_b32 v245, v252, v233
    v_and_b32 v246, v252, v234
    v_and_b32 v247, v252, v235
    s_nop 1
    v_mfma_f32_16x16x32_bf16 v[224:227], v[244:247], v[184:187], v[224:227]
    v_cvt_pk_bf16_f32 v252, v222, v222
    v_and_b32 v248, v252, v232
    v_and_b32 v249, v252, v233
    v_and_b32 v250, v252, v234
    v_and_b32 v251, v252, v235
    s_nop 1
    v_mfma_f32_16x16x32_bf16 v[228:231], v[248:251], v[184:187], v[228:231]
    v_cvt_pk_bf16_f32 v252, v219, v219
    v_and_b32 v240, v252, v232
    v_and_b32 v241, v252, v233
    v_and_b32 v242, v252, v234
    v_and_b32 v243, v252, v235
    s_nop 1
    v_mfma_f32_16x16x32_bf16 v[224:227], v[240:243], v[188:191], v[224:227]
    v_cvt_pk_bf16_f32 v252, v223, v223
    v_and_b32 v244, v252, v232
    v_and_b32 v245, v252, v233
    v_and_b32 v246, v252, v234
    v_and_b32 v247, v252, v235
    s_nop 1
    v_mfma_f32_16x16x32_bf16 v[228:231], v[244:247], v[188:191], v[228:231]
    s_add_u32 s20, s18, 16384
    buffer_load_dwordx4 v[128:131], v7, s[8:11], s20 offen offset:0 nt
    buffer_load_dwordx4 v[132:135], v7, s[8:11], s20 offen offset:256 nt
    buffer_load_dwordx4 v[136:139], v7, s[8:11], s20 offen offset:512 nt
    buffer_load_dwordx4 v[140:143], v7, s[8:11], s20 offen offset:768 nt
    s_add_u32 s20, s18, 20480
    buffer_load_dwordx4 v[144:147], v7, s[8:11], s20 offen offset:0 nt
    buffer_load_dwordx4 v[148:151], v7, s[8:11], s20 offen offset:256 nt
    buffer_load_dwordx4 v[152:155], v7, s[8:11], s20 offen offset:512 nt
    buffer_load_dwordx4 v[156:159], v7, s[8:11], s20 offen offset:768 nt
    s_add_u32 s20, s18, 24576
    buffer_load_dwordx4 v[160:163], v7, s[8:11], s20 offen offset:0 nt
    buffer_load_dwordx4 v[164:167], v7, s[8:11], s20 offen offset:256 nt
    buffer_load_dwordx4 v[168:171], v7, s[8:11], s20 offen offset:512 nt
    buffer_load_dwordx4 v[172:175], v7, s[8:11], s20 offen offset:768 nt
    s_add_u32 s20, s18, 28672
    buffer_load_dwordx4 v[176:179], v7, s[8:11], s20 offen offset:0 nt
    buffer_load_dwordx4 v[180:183], v7, s[8:11], s20 offen offset:256 nt
    buffer_load_dwordx4 v[184:187], v7, s[8:11], s20 offen offset:512 nt
    buffer_load_dwordx4 v[188:191], v7, s[8:11], s20 offen offset:768 nt
    s_nop 7
    s_nop 1
    s_waitcnt vmcnt(16)
    v_mfma_f32_16x16x32_bf16 v[192:195], v[64:67], v[16:19], 0
    v_mfma_f32_16x16x32_bf16 v[192:195], v[68:71], v[20:23], v[192:195]
    v_mfma_f32_16x16x32_bf16 v[192:195], v[72:75], v[24:27], v[192:195]
    v_mfma_f32_16x16x32_bf16 v[192:195], v[76:79], v[28:31], v[192:195]
    v_mfma_f32_16x16x32_bf16 v[196:199], v[64:67], v[32:35], 0
    v_mfma_f32_16x16x32_bf16 v[196:199], v[68:71], v[36:39], v[196:199]
    v_mfma_f32_16x16x32_bf16 v[196:199], v[72:75], v[40:43], v[196:199]
    v_mfma_f32_16x16x32_bf16 v[196:199], v[76:79], v[44:47], v[196:199]
    v_mfma_f32_16x16x32_bf16 v[200:203], v[80:83], v[16:19], 0
    v_mfma_f32_16x16x32_bf16 v[200:203], v[84:87], v[20:23], v[200:203]
    v_mfma_f32_16x16x32_bf16 v[200:203], v[88:91], v[24:27], v[200:203]
    v_mfma_f32_16x16x32_bf16 v[200:203], v[92:95], v[28:31], v[200:203]
    v_mfma_f32_16x16x32_bf16 v[204:207], v[80:83], v[32:35], 0
    v_mfma_f32_16x16x32_bf16 v[204:207], v[84:87], v[36:39], v[204:207]
    v_mfma_f32_16x16x32_bf16 v[204:207], v[88:91], v[40:43], v[204:207]
    v_mfma_f32_16x16x32_bf16 v[204:207], v[92:95], v[44:47], v[204:207]
    v_mfma_f32_16x16x32_bf16 v[208:211], v[96:99], v[16:19], 0
    v_mfma_f32_16x16x32_bf16 v[208:211], v[100:103], v[20:23], v[208:211]
    v_mfma_f32_16x16x32_bf16 v[208:211], v[104:107], v[24:27], v[208:211]
    v_mfma_f32_16x16x32_bf16 v[208:211], v[108:111], v[28:31], v[208:211]
    v_mfma_f32_16x16x32_bf16 v[212:215], v[96:99], v[32:35], 0
    v_mfma_f32_16x16x32_bf16 v[212:215], v[100:103], v[36:39], v[212:215]
    v_mfma_f32_16x16x32_bf16 v[212:215], v[104:107], v[40:43], v[212:215]
    v_mfma_f32_16x16x32_bf16 v[212:215], v[108:111], v[44:47], v[212:215]
    v_mfma_f32_16x16x32_bf16 v[216:219], v[112:115], v[16:19], 0
    v_mfma_f32_16x16x32_bf16 v[216:219], v[116:119], v[20:23], v[216:219]
    v_mfma_f32_16x16x32_bf16 v[216:219], v[120:123], v[24:27], v[216:219]
    v_mfma_f32_16x16x32_bf16 v[216:219], v[124:127], v[28:31], v[216:219]
    v_mfma_f32_16x16x32_bf16 v[220:223], v[112:115], v[32:35], 0
    v_mfma_f32_16x16x32_bf16 v[220:223], v[116:119], v[36:39], v[220:223]
    v_mfma_f32_16x16x32_bf16 v[220:223], v[120:123], v[40:43], v[220:223]
    v_mfma_f32_16x16x32_bf16 v[220:223], v[124:127], v[44:47], v[220:223]
    s_add_u32 s20, s18, 32768
    buffer_load_dwordx4 v[64:67], v6, s[4:7], s20 offen offset:0 nt
    buffer_load_dwordx4 v[68:71], v6, s[4:7], s20 offen offset:64 nt
    buffer_load_dwordx4 v[72:75], v6, s[4:7], s20 offen offset:128 nt
    buffer_load_dwordx4 v[76:79], v6, s[4:7], s20 offen offset:192 nt
    s_add_u32 s20, s18, 36864
    buffer_load_dwordx4 v[80:83], v6, s[4:7], s20 offen offset:0 nt
    buffer_load_dwordx4 v[84:87], v6, s[4:7], s20 offen offset:64 nt
    buffer_load_dwordx4 v[88:91], v6, s[4:7], s20 offen offset:128 nt
    buffer_load_dwordx4 v[92:95], v6, s[4:7], s20 offen offset:192 nt
    s_add_u32 s20, s18, 40960
    buffer_load_dwordx4 v[96:99], v6, s[4:7], s20 offen offset:0 nt
    buffer_load_dwordx4 v[100:103], v6, s[4:7], s20 offen offset:64 nt
    buffer_load_dwordx4 v[104:107], v6, s[4:7], s20 offen offset:128 nt
    buffer_load_dwordx4 v[108:111], v6, s[4:7], s20 offen offset:192 nt
    s_add_u32 s20, s18, 45056
    buffer_load_dwordx4 v[112:115], v6, s[4:7], s20 offen offset:0 nt
    buffer_load_dwordx4 v[116:119], v6, s[4:7], s20 offen offset:64 nt
    buffer_load_dwordx4 v[120:123], v6, s[4:7], s20 offen offset:128 nt
    buffer_load_dwordx4 v[124:127], v6, s[4:7], s20 offen offset:192 nt
    s_nop 7
    s_nop 1
    v_max3_f32 v240, v192, v193, v194
    v_max3_f32 v240, v240, v195, v200
    v_max3_f32 v240, v240, v201, v202
    v_max3_f32 v240, v240, v203, v208
    v_max3_f32 v240, v240, v209, v210
    v_max3_f32 v240, v240, v211, v216
    v_max3_f32 v240, v240, v217, v218
    v_max3_f32 v240, v240, v219, v236
    v_mov_b32 v242, v240
    s_nop 1
    v_permlane16_swap_b32 v242, v240
    s_nop 1
    v_max_f32 v240, v240, v242
    v_mov_b32 v242, v240
    s_nop 1
    v_permlane32_swap_b32 v242, v240
    s_nop 1
    v_max_f32 v240, v240, v242
    v_sub_f32 v243, v236, v240
    v_mul_f32 v243, 0x3e0293ee, v243
    v_exp_f32 v244, v243
    v_mov_b32 v236, v240
    v_mul_f32 v243, 0x3e0293ee, v240
    s_mov_b32 s21, 0x3e0293ee
    v_fma_f32 v192, v192, s21, -v243
    v_fma_f32 v193, v193, s21, -v243
    v_fma_f32 v194, v194, s21, -v243
    v_fma_f32 v195, v195, s21, -v243
    v_fma_f32 v200, v200, s21, -v243
    v_fma_f32 v201, v201, s21, -v243
    v_fma_f32 v202, v202, s21, -v243
    v_fma_f32 v203, v203, s21, -v243
    v_fma_f32 v208, v208, s21, -v243
    v_fma_f32 v209, v209, s21, -v243
    v_fma_f32 v210, v210, s21, -v243
    v_fma_f32 v211, v211, s21, -v243
    v_fma_f32 v216, v216, s21, -v243
    v_fma_f32 v217, v217, s21, -v243
    v_fma_f32 v218, v218, s21, -v243
    v_fma_f32 v219, v219, s21, -v243
    v_exp_f32 v192, v192
    v_exp_f32 v193, v193
    v_exp_f32 v194, v194
    v_exp_f32 v195, v195
    v_exp_f32 v200, v200
    v_exp_f32 v201, v201
    v_exp_f32 v202, v202
    v_exp_f32 v203, v203
    v_exp_f32 v208, v208
    v_exp_f32 v209, v209
    v_exp_f32 v210, v210
    v_exp_f32 v211, v211
    v_exp_f32 v216, v216
    v_exp_f32 v217, v217
    v_exp_f32 v218, v218
    v_exp_f32 v219, v219
    s_nop 0
    v_mul_f32 v238, v238, v244
    v_add_f32 v238, v238, v192
    v_add_f32 v238, v238, v193
    v_add_f32 v238, v238, v194
    v_add_f32 v238, v238, v195
    v_add_f32 v238, v238, v200
    v_add_f32 v238, v238, v201
    v_add_f32 v238, v238, v202
    v_add_f32 v238, v238, v203
    v_add_f32 v238, v238, v208
    v_add_f32 v238, v238, v209
    v_add_f32 v238, v238, v210
    v_add_f32 v238, v238, v211
    v_add_f32 v238, v238, v216
    v_add_f32 v238, v238, v217
    v_add_f32 v238, v238, v218
    v_add_f32 v238, v238, v219
    v_max3_f32 v241, v196, v197, v198
    v_max3_f32 v241, v241, v199, v204
    v_max3_f32 v241, v241, v205, v206
    v_max3_f32 v241, v241, v207, v212
    v_max3_f32 v241, v241, v213, v214
    v_max3_f32 v241, v241, v215, v220
    v_max3_f32 v241, v241, v221, v222
    v_max3_f32 v241, v241, v223, v237
    v_mov_b32 v242, v241
    s_nop 1
    v_permlane16_swap_b32 v242, v241
    s_nop 1
    v_max_f32 v241, v241, v242
    v_mov_b32 v242, v241
    s_nop 1
    v_permlane32_swap_b32 v242, v241
    s_nop 1
    v_max_f32 v241, v241, v242
    v_sub_f32 v243, v237, v241
    v_mul_f32 v243, 0x3e0293ee, v243
    v_exp_f32 v245, v243
    v_mov_b32 v237, v241
    v_mul_f32 v243, 0x3e0293ee, v241
    s_mov_b32 s21, 0x3e0293ee
    v_fma_f32 v196, v196, s21, -v243
    v_fma_f32 v197, v197, s21, -v243
    v_fma_f32 v198, v198, s21, -v243
    v_fma_f32 v199, v199, s21, -v243
    v_fma_f32 v204, v204, s21, -v243
    v_fma_f32 v205, v205, s21, -v243
    v_fma_f32 v206, v206, s21, -v243
    v_fma_f32 v207, v207, s21, -v243
    v_fma_f32 v212, v212, s21, -v243
    v_fma_f32 v213, v213, s21, -v243
    v_fma_f32 v214, v214, s21, -v243
    v_fma_f32 v215, v215, s21, -v243
    v_fma_f32 v220, v220, s21, -v243
    v_fma_f32 v221, v221, s21, -v243
    v_fma_f32 v222, v222, s21, -v243
    v_fma_f32 v223, v223, s21, -v243
    v_exp_f32 v196, v196
    v_exp_f32 v197, v197
    v_exp_f32 v198, v198
    v_exp_f32 v199, v199
    v_exp_f32 v204, v204
    v_exp_f32 v205, v205
    v_exp_f32 v206, v206
    v_exp_f32 v207, v207
    v_exp_f32 v212, v212
    v_exp_f32 v213, v213
    v_exp_f32 v214, v214
    v_exp_f32 v215, v215
    v_exp_f32 v220, v220
    v_exp_f32 v221, v221
    v_exp_f32 v222, v222
    v_exp_f32 v223, v223
    s_nop 0
    v_mul_f32 v239, v239, v245
    v_add_f32 v239, v239, v196
    v_add_f32 v239, v239, v197
    v_add_f32 v239, v239, v198
    v_add_f32 v239, v239, v199
    v_add_f32 v239, v239, v204
    v_add_f32 v239, v239, v205
    v_add_f32 v239, v239, v206
    v_add_f32 v239, v239, v207
    v_add_f32 v239, v239, v212
    v_add_f32 v239, v239, v213
    v_add_f32 v239, v239, v214
    v_add_f32 v239, v239, v215
    v_add_f32 v239, v239, v220
    v_add_f32 v239, v239, v221
    v_add_f32 v239, v239, v222
    v_add_f32 v239, v239, v223
    s_nop 1
    v_mul_f32_dpp v224, v244, v224 quad_perm:[0,0,2,2] row_mask:0xf bank_mask:0xf
    v_mul_f32_dpp v225, v244, v225 quad_perm:[1,1,3,3] row_mask:0xf bank_mask:0xf
    v_mul_f32_dpp v226, v244, v226 quad_perm:[0,0,2,2] row_mask:0xf bank_mask:0xf
    v_mul_f32_dpp v227, v244, v227 quad_perm:[1,1,3,3] row_mask:0xf bank_mask:0xf
    v_mul_f32_dpp v228, v245, v228 quad_perm:[0,0,2,2] row_mask:0xf bank_mask:0xf
    v_mul_f32_dpp v229, v245, v229 quad_perm:[1,1,3,3] row_mask:0xf bank_mask:0xf
    v_mul_f32_dpp v230, v245, v230 quad_perm:[0,0,2,2] row_mask:0xf bank_mask:0xf
    v_mul_f32_dpp v231, v245, v231 quad_perm:[1,1,3,3] row_mask:0xf bank_mask:0xf
    s_waitcnt vmcnt(16)
    v_cvt_pk_bf16_f32 v252, v192, v192
    v_and_b32 v240, v252, v232
    v_and_b32 v241, v252, v233
    v_and_b32 v242, v252, v234
    v_and_b32 v243, v252, v235
    s_nop 1
    v_mfma_f32_16x16x32_bf16 v[224:227], v[240:243], v[128:131], v[224:227]
    v_cvt_pk_bf16_f32 v252, v196, v196
    v_and_b32 v244, v252, v232
    v_and_b32 v245, v252, v233
    v_and_b32 v246, v252, v234
    v_and_b32 v247, v252, v235
    s_nop 1
    v_mfma_f32_16x16x32_bf16 v[228:231], v[244:247], v[128:131], v[228:231]
    v_cvt_pk_bf16_f32 v252, v193, v193
    v_and_b32 v248, v252, v232
    v_and_b32 v249, v252, v233
    v_and_b32 v250, v252, v234
    v_and_b32 v251, v252, v235
    s_nop 1
    v_mfma_f32_16x16x32_bf16 v[224:227], v[248:251], v[132:135], v[224:227]
    v_cvt_pk_bf16_f32 v252, v197, v197
    v_and_b32 v240, v252, v232
    v_and_b32 v241, v252, v233
    v_and_b32 v242, v252, v234
    v_and_b32 v243, v252, v235
    s_nop 1
    v_mfma_f32_16x16x32_bf16 v[228:231], v[240:243], v[132:135], v[228:231]
    v_cvt_pk_bf16_f32 v252, v194, v194
    v_and_b32 v244, v252, v232
    v_and_b32 v245, v252, v233
    v_and_b32 v246, v252, v234
    v_and_b32 v247, v252, v235
    s_nop 1
    v_mfma_f32_16x16x32_bf16 v[224:227], v[244:247], v[136:139], v[224:227]
    v_cvt_pk_bf16_f32 v252, v198, v198
    v_and_b32 v248, v252, v232
    v_and_b32 v249, v252, v233
    v_and_b32 v250, v252, v234
    v_and_b32 v251, v252, v235
    s_nop 1
    v_mfma_f32_16x16x32_bf16 v[228:231], v[248:251], v[136:139], v[228:231]
    v_cvt_pk_bf16_f32 v252, v195, v195
    v_and_b32 v240, v252, v232
    v_and_b32 v241, v252, v233
    v_and_b32 v242, v252, v234
    v_and_b32 v243, v252, v235
    s_nop 1
    v_mfma_f32_16x16x32_bf16 v[224:227], v[240:243], v[140:143], v[224:227]
    v_cvt_pk_bf16_f32 v252, v199, v199
    v_and_b32 v244, v252, v232
    v_and_b32 v245, v252, v233
    v_and_b32 v246, v252, v234
    v_and_b32 v247, v252, v235
    s_nop 1
    v_mfma_f32_16x16x32_bf16 v[228:231], v[244:247], v[140:143], v[228:231]
    v_cvt_pk_bf16_f32 v252, v200, v200
    v_and_b32 v248, v252, v232
    v_and_b32 v249, v252, v233
    v_and_b32 v250, v252, v234
    v_and_b32 v251, v252, v235
    s_nop 1
    v_mfma_f32_16x16x32_bf16 v[224:227], v[248:251], v[144:147], v[224:227]
    v_cvt_pk_bf16_f32 v252, v204, v204
    v_and_b32 v240, v252, v232
    v_and_b32 v241, v252, v233
    v_and_b32 v242, v252, v234
    v_and_b32 v243, v252, v235
    s_nop 1
    v_mfma_f32_16x16x32_bf16 v[228:231], v[240:243], v[144:147], v[228:231]
    v_cvt_pk_bf16_f32 v252, v201, v201
    v_and_b32 v244, v252, v232
    v_and_b32 v245, v252, v233
    v_and_b32 v246, v252, v234
    v_and_b32 v247, v252, v235
    s_nop 1
    v_mfma_f32_16x16x32_bf16 v[224:227], v[244:247], v[148:151], v[224:227]
    v_cvt_pk_bf16_f32 v252, v205, v205
    v_and_b32 v248, v252, v232
    v_and_b32 v249, v252, v233
    v_and_b32 v250, v252, v234
    v_and_b32 v251, v252, v235
    s_nop 1
    v_mfma_f32_16x16x32_bf16 v[228:231], v[248:251], v[148:151], v[228:231]
    v_cvt_pk_bf16_f32 v252, v202, v202
    v_and_b32 v240, v252, v232
    v_and_b32 v241, v252, v233
    v_and_b32 v242, v252, v234
    v_and_b32 v243, v252, v235
    s_nop 1
    v_mfma_f32_16x16x32_bf16 v[224:227], v[240:243], v[152:155], v[224:227]
    v_cvt_pk_bf16_f32 v252, v206, v206
    v_and_b32 v244, v252, v232
    v_and_b32 v245, v252, v233
    v_and_b32 v246, v252, v234
    v_and_b32 v247, v252, v235
    s_nop 1
    v_mfma_f32_16x16x32_bf16 v[228:231], v[244:247], v[152:155], v[228:231]
    v_cvt_pk_bf16_f32 v252, v203, v203
    v_and_b32 v248, v252, v232
    v_and_b32 v249, v252, v233
    v_and_b32 v250, v252, v234
    v_and_b32 v251, v252, v235
    s_nop 1
    v_mfma_f32_16x16x32_bf16 v[224:227], v[248:251], v[156:159], v[224:227]
    v_cvt_pk_bf16_f32 v252, v207, v207
    v_and_b32 v240, v252, v232
    v_and_b32 v241, v252, v233
    v_and_b32 v242, v252, v234
    v_and_b32 v243, v252, v235
    s_nop 1
    v_mfma_f32_16x16x32_bf16 v[228:231], v[240:243], v[156:159], v[228:231]
    v_cvt_pk_bf16_f32 v252, v208, v208
    v_and_b32 v244, v252, v232
    v_and_b32 v245, v252, v233
    v_and_b32 v246, v252, v234
    v_and_b32 v247, v252, v235
    s_nop 1
    v_mfma_f32_16x16x32_bf16 v[224:227], v[244:247], v[160:163], v[224:227]
    v_cvt_pk_bf16_f32 v252, v212, v212
    v_and_b32 v248, v252, v232
    v_and_b32 v249, v252, v233
    v_and_b32 v250, v252, v234
    v_and_b32 v251, v252, v235
    s_nop 1
    v_mfma_f32_16x16x32_bf16 v[228:231], v[248:251], v[160:163], v[228:231]
    v_cvt_pk_bf16_f32 v252, v209, v209
    v_and_b32 v240, v252, v232
    v_and_b32 v241, v252, v233
    v_and_b32 v242, v252, v234
    v_and_b32 v243, v252, v235
    s_nop 1
    v_mfma_f32_16x16x32_bf16 v[224:227], v[240:243], v[164:167], v[224:227]
    v_cvt_pk_bf16_f32 v252, v213, v213
    v_and_b32 v244, v252, v232
    v_and_b32 v245, v252, v233
    v_and_b32 v246, v252, v234
    v_and_b32 v247, v252, v235
    s_nop 1
    v_mfma_f32_16x16x32_bf16 v[228:231], v[244:247], v[164:167], v[228:231]
    v_cvt_pk_bf16_f32 v252, v210, v210
    v_and_b32 v248, v252, v232
    v_and_b32 v249, v252, v233
    v_and_b32 v250, v252, v234
    v_and_b32 v251, v252, v235
    s_nop 1
    v_mfma_f32_16x16x32_bf16 v[224:227], v[248:251], v[168:171], v[224:227]
    v_cvt_pk_bf16_f32 v252, v214, v214
    v_and_b32 v240, v252, v232
    v_and_b32 v241, v252, v233
    v_and_b32 v242, v252, v234
    v_and_b32 v243, v252, v235
    s_nop 1
    v_mfma_f32_16x16x32_bf16 v[228:231], v[240:243], v[168:171], v[228:231]
    v_cvt_pk_bf16_f32 v252, v211, v211
    v_and_b32 v244, v252, v232
    v_and_b32 v245, v252, v233
    v_and_b32 v246, v252, v234
    v_and_b32 v247, v252, v235
    s_nop 1
    v_mfma_f32_16x16x32_bf16 v[224:227], v[244:247], v[172:175], v[224:227]
    v_cvt_pk_bf16_f32 v252, v215, v215
    v_and_b32 v248, v252, v232
    v_and_b32 v249, v252, v233
    v_and_b32 v250, v252, v234
    v_and_b32 v251, v252, v235
    s_nop 1
    v_mfma_f32_16x16x32_bf16 v[228:231], v[248:251], v[172:175], v[228:231]
    v_cvt_pk_bf16_f32 v252, v216, v216
    v_and_b32 v240, v252, v232
    v_and_b32 v241, v252, v233
    v_and_b32 v242, v252, v234
    v_and_b32 v243, v252, v235
    s_nop 1
    v_mfma_f32_16x16x32_bf16 v[224:227], v[240:243], v[176:179], v[224:227]
    v_cvt_pk_bf16_f32 v252, v220, v220
    v_and_b32 v244, v252, v232
    v_and_b32 v245, v252, v233
    v_and_b32 v246, v252, v234
    v_and_b32 v247, v252, v235
    s_nop 1
    v_mfma_f32_16x16x32_bf16 v[228:231], v[244:247], v[176:179], v[228:231]
    v_cvt_pk_bf16_f32 v252, v217, v217
    v_and_b32 v248, v252, v232
    v_and_b32 v249, v252, v233
    v_and_b32 v250, v252, v234
    v_and_b32 v251, v252, v235
    s_nop 1
    v_mfma_f32_16x16x32_bf16 v[224:227], v[248:251], v[180:183], v[224:227]
    v_cvt_pk_bf16_f32 v252, v221, v221
    v_and_b32 v240, v252, v232
    v_and_b32 v241, v252, v233
    v_and_b32 v242, v252, v234
    v_and_b32 v243, v252, v235
    s_nop 1
    v_mfma_f32_16x16x32_bf16 v[228:231], v[240:243], v[180:183], v[228:231]
    v_cvt_pk_bf16_f32 v252, v218, v218
    v_and_b32 v244, v252, v232
    v_and_b32 v245, v252, v233
    v_and_b32 v246, v252, v234
    v_and_b32 v247, v252, v235
    s_nop 1
    v_mfma_f32_16x16x32_bf16 v[224:227], v[244:247], v[184:187], v[224:227]
    v_cvt_pk_bf16_f32 v252, v222, v222
    v_and_b32 v248, v252, v232
    v_and_b32 v249, v252, v233
    v_and_b32 v250, v252, v234
    v_and_b32 v251, v252, v235
    s_nop 1
    v_mfma_f32_16x16x32_bf16 v[228:231], v[248:251], v[184:187], v[228:231]
    v_cvt_pk_bf16_f32 v252, v219, v219
    v_and_b32 v240, v252, v232
    v_and_b32 v241, v252, v233
    v_and_b32 v242, v252, v234
    v_and_b32 v243, v252, v235
    s_nop 1
    v_mfma_f32_16x16x32_bf16 v[224:227], v[240:243], v[188:191], v[224:227]
    v_cvt_pk_bf16_f32 v252, v223, v223
    v_and_b32 v244, v252, v232
    v_and_b32 v245, v252, v233
    v_and_b32 v246, v252, v234
    v_and_b32 v247, v252, v235
    s_nop 1
    v_mfma_f32_16x16x32_bf16 v[228:231], v[244:247], v[188:191], v[228:231]
    s_add_u32 s20, s18, 32768
    buffer_load_dwordx4 v[128:131], v7, s[8:11], s20 offen offset:0 nt
    buffer_load_dwordx4 v[132:135], v7, s[8:11], s20 offen offset:256 nt
    buffer_load_dwordx4 v[136:139], v7, s[8:11], s20 offen offset:512 nt
    buffer_load_dwordx4 v[140:143], v7, s[8:11], s20 offen offset:768 nt
    s_add_u32 s20, s18, 36864
    buffer_load_dwordx4 v[144:147], v7, s[8:11], s20 offen offset:0 nt
    buffer_load_dwordx4 v[148:151], v7, s[8:11], s20 offen offset:256 nt
    buffer_load_dwordx4 v[152:155], v7, s[8:11], s20 offen offset:512 nt
    buffer_load_dwordx4 v[156:159], v7, s[8:11], s20 offen offset:768 nt
    s_add_u32 s20, s18, 40960
    buffer_load_dwordx4 v[160:163], v7, s[8:11], s20 offen offset:0 nt
    buffer_load_dwordx4 v[164:167], v7, s[8:11], s20 offen offset:256 nt
    buffer_load_dwordx4 v[168:171], v7, s[8:11], s20 offen offset:512 nt
    buffer_load_dwordx4 v[172:175], v7, s[8:11], s20 offen offset:768 nt
    s_add_u32 s20, s18, 45056
    buffer_load_dwordx4 v[176:179], v7, s[8:11], s20 offen offset:0 nt
    buffer_load_dwordx4 v[180:183], v7, s[8:11], s20 offen offset:256 nt
    buffer_load_dwordx4 v[184:187], v7, s[8:11], s20 offen offset:512 nt
    buffer_load_dwordx4 v[188:191], v7, s[8:11], s20 offen offset:768 nt
    s_nop 7
    s_nop 1
    s_waitcnt vmcnt(16)
    v_mfma_f32_16x16x32_bf16 v[192:195], v[64:67], v[16:19], 0
    v_mfma_f32_16x16x32_bf16 v[192:195], v[68:71], v[20:23], v[192:195]
    v_mfma_f32_16x16x32_bf16 v[192:195], v[72:75], v[24:27], v[192:195]
    v_mfma_f32_16x16x32_bf16 v[192:195], v[76:79], v[28:31], v[192:195]
    v_mfma_f32_16x16x32_bf16 v[196:199], v[64:67], v[32:35], 0
    v_mfma_f32_16x16x32_bf16 v[196:199], v[68:71], v[36:39], v[196:199]
    v_mfma_f32_16x16x32_bf16 v[196:199], v[72:75], v[40:43], v[196:199]
    v_mfma_f32_16x16x32_bf16 v[196:199], v[76:79], v[44:47], v[196:199]
    v_mfma_f32_16x16x32_bf16 v[200:203], v[80:83], v[16:19], 0
    v_mfma_f32_16x16x32_bf16 v[200:203], v[84:87], v[20:23], v[200:203]
    v_mfma_f32_16x16x32_bf16 v[200:203], v[88:91], v[24:27], v[200:203]
    v_mfma_f32_16x16x32_bf16 v[200:203], v[92:95], v[28:31], v[200:203]
    v_mfma_f32_16x16x32_bf16 v[204:207], v[80:83], v[32:35], 0
    v_mfma_f32_16x16x32_bf16 v[204:207], v[84:87], v[36:39], v[204:207]
    v_mfma_f32_16x16x32_bf16 v[204:207], v[88:91], v[40:43], v[204:207]
    v_mfma_f32_16x16x32_bf16 v[204:207], v[92:95], v[44:47], v[204:207]
    v_mfma_f32_16x16x32_bf16 v[208:211], v[96:99], v[16:19], 0
    v_mfma_f32_16x16x32_bf16 v[208:211], v[100:103], v[20:23], v[208:211]
    v_mfma_f32_16x16x32_bf16 v[208:211], v[104:107], v[24:27], v[208:211]
    v_mfma_f32_16x16x32_bf16 v[208:211], v[108:111], v[28:31], v[208:211]
    v_mfma_f32_16x16x32_bf16 v[212:215], v[96:99], v[32:35], 0
    v_mfma_f32_16x16x32_bf16 v[212:215], v[100:103], v[36:39], v[212:215]
    v_mfma_f32_16x16x32_bf16 v[212:215], v[104:107], v[40:43], v[212:215]
    v_mfma_f32_16x16x32_bf16 v[212:215], v[108:111], v[44:47], v[212:215]
    v_mfma_f32_16x16x32_bf16 v[216:219], v[112:115], v[16:19], 0
    v_mfma_f32_16x16x32_bf16 v[216:219], v[116:119], v[20:23], v[216:219]
    v_mfma_f32_16x16x32_bf16 v[216:219], v[120:123], v[24:27], v[216:219]
    v_mfma_f32_16x16x32_bf16 v[216:219], v[124:127], v[28:31], v[216:219]
    v_mfma_f32_16x16x32_bf16 v[220:223], v[112:115], v[32:35], 0
    v_mfma_f32_16x16x32_bf16 v[220:223], v[116:119], v[36:39], v[220:223]
    v_mfma_f32_16x16x32_bf16 v[220:223], v[120:123], v[40:43], v[220:223]
    v_mfma_f32_16x16x32_bf16 v[220:223], v[124:127], v[44:47], v[220:223]
    s_add_u32 s20, s18, 49152
    buffer_load_dwordx4 v[64:67], v6, s[4:7], s20 offen offset:0 nt
    buffer_load_dwordx4 v[68:71], v6, s[4:7], s20 offen offset:64 nt
    buffer_load_dwordx4 v[72:75], v6, s[4:7], s20 offen offset:128 nt
    buffer_load_dwordx4 v[76:79], v6, s[4:7], s20 offen offset:192 nt
    s_add_u32 s20, s18, 53248
    buffer_load_dwordx4 v[80:83], v6, s[4:7], s20 offen offset:0 nt
    buffer_load_dwordx4 v[84:87], v6, s[4:7], s20 offen offset:64 nt
    buffer_load_dwordx4 v[88:91], v6, s[4:7], s20 offen offset:128 nt
    buffer_load_dwordx4 v[92:95], v6, s[4:7], s20 offen offset:192 nt
    s_add_u32 s20, s18, 57344
    buffer_load_dwordx4 v[96:99], v6, s[4:7], s20 offen offset:0 nt
    buffer_load_dwordx4 v[100:103], v6, s[4:7], s20 offen offset:64 nt
    buffer_load_dwordx4 v[104:107], v6, s[4:7], s20 offen offset:128 nt
    buffer_load_dwordx4 v[108:111], v6, s[4:7], s20 offen offset:192 nt
    s_add_u32 s20, s18, 61440
    buffer_load_dwordx4 v[112:115], v6, s[4:7], s20 offen offset:0 nt
    buffer_load_dwordx4 v[116:119], v6, s[4:7], s20 offen offset:64 nt
    buffer_load_dwordx4 v[120:123], v6, s[4:7], s20 offen offset:128 nt
    buffer_load_dwordx4 v[124:127], v6, s[4:7], s20 offen offset:192 nt
    s_nop 7
    s_nop 1
    v_max3_f32 v240, v192, v193, v194
    v_max3_f32 v240, v240, v195, v200
    v_max3_f32 v240, v240, v201, v202
    v_max3_f32 v240, v240, v203, v208
    v_max3_f32 v240, v240, v209, v210
    v_max3_f32 v240, v240, v211, v216
    v_max3_f32 v240, v240, v217, v218
    v_max3_f32 v240, v240, v219, v236
    v_mov_b32 v242, v240
    s_nop 1
    v_permlane16_swap_b32 v242, v240
    s_nop 1
    v_max_f32 v240, v240, v242
    v_mov_b32 v242, v240
    s_nop 1
    v_permlane32_swap_b32 v242, v240
    s_nop 1
    v_max_f32 v240, v240, v242
    v_sub_f32 v243, v236, v240
    v_mul_f32 v243, 0x3e0293ee, v243
    v_exp_f32 v244, v243
    v_mov_b32 v236, v240
    v_mul_f32 v243, 0x3e0293ee, v240
    s_mov_b32 s21, 0x3e0293ee
    v_fma_f32 v192, v192, s21, -v243
    v_fma_f32 v193, v193, s21, -v243
    v_fma_f32 v194, v194, s21, -v243
    v_fma_f32 v195, v195, s21, -v243
    v_fma_f32 v200, v200, s21, -v243
    v_fma_f32 v201, v201, s21, -v243
    v_fma_f32 v202, v202, s21, -v243
    v_fma_f32 v203, v203, s21, -v243
    v_fma_f32 v208, v208, s21, -v243
    v_fma_f32 v209, v209, s21, -v243
    v_fma_f32 v210, v210, s21, -v243
    v_fma_f32 v211, v211, s21, -v243
    v_fma_f32 v216, v216, s21, -v243
    v_fma_f32 v217, v217, s21, -v243
    v_fma_f32 v218, v218, s21, -v243
    v_fma_f32 v219, v219, s21, -v243
    v_exp_f32 v192, v192
    v_exp_f32 v193, v193
    v_exp_f32 v194, v194
    v_exp_f32 v195, v195
    v_exp_f32 v200, v200
    v_exp_f32 v201, v201
    v_exp_f32 v202, v202
    v_exp_f32 v203, v203
    v_exp_f32 v208, v208
    v_exp_f32 v209, v209
    v_exp_f32 v210, v210
    v_exp_f32 v211, v211
    v_exp_f32 v216, v216
    v_exp_f32 v217, v217
    v_exp_f32 v218, v218
    v_exp_f32 v219, v219
    s_nop 0
    v_mul_f32 v238, v238, v244
    v_add_f32 v238, v238, v192
    v_add_f32 v238, v238, v193
    v_add_f32 v238, v238, v194
    v_add_f32 v238, v238, v195
    v_add_f32 v238, v238, v200
    v_add_f32 v238, v238, v201
    v_add_f32 v238, v238, v202
    v_add_f32 v238, v238, v203
    v_add_f32 v238, v238, v208
    v_add_f32 v238, v238, v209
    v_add_f32 v238, v238, v210
    v_add_f32 v238, v238, v211
    v_add_f32 v238, v238, v216
    v_add_f32 v238, v238, v217
    v_add_f32 v238, v238, v218
    v_add_f32 v238, v238, v219
    v_max3_f32 v241, v196, v197, v198
    v_max3_f32 v241, v241, v199, v204
    v_max3_f32 v241, v241, v205, v206
    v_max3_f32 v241, v241, v207, v212
    v_max3_f32 v241, v241, v213, v214
    v_max3_f32 v241, v241, v215, v220
    v_max3_f32 v241, v241, v221, v222
    v_max3_f32 v241, v241, v223, v237
    v_mov_b32 v242, v241
    s_nop 1
    v_permlane16_swap_b32 v242, v241
    s_nop 1
    v_max_f32 v241, v241, v242
    v_mov_b32 v242, v241
    s_nop 1
    v_permlane32_swap_b32 v242, v241
    s_nop 1
    v_max_f32 v241, v241, v242
    v_sub_f32 v243, v237, v241
    v_mul_f32 v243, 0x3e0293ee, v243
    v_exp_f32 v245, v243
    v_mov_b32 v237, v241
    v_mul_f32 v243, 0x3e0293ee, v241
    s_mov_b32 s21, 0x3e0293ee
    v_fma_f32 v196, v196, s21, -v243
    v_fma_f32 v197, v197, s21, -v243
    v_fma_f32 v198, v198, s21, -v243
    v_fma_f32 v199, v199, s21, -v243
    v_fma_f32 v204, v204, s21, -v243
    v_fma_f32 v205, v205, s21, -v243
    v_fma_f32 v206, v206, s21, -v243
    v_fma_f32 v207, v207, s21, -v243
    v_fma_f32 v212, v212, s21, -v243
    v_fma_f32 v213, v213, s21, -v243
    v_fma_f32 v214, v214, s21, -v243
    v_fma_f32 v215, v215, s21, -v243
    v_fma_f32 v220, v220, s21, -v243
    v_fma_f32 v221, v221, s21, -v243
    v_fma_f32 v222, v222, s21, -v243
    v_fma_f32 v223, v223, s21, -v243
    v_exp_f32 v196, v196
    v_exp_f32 v197, v197
    v_exp_f32 v198, v198
    v_exp_f32 v199, v199
    v_exp_f32 v204, v204
    v_exp_f32 v205, v205
    v_exp_f32 v206, v206
    v_exp_f32 v207, v207
    v_exp_f32 v212, v212
    v_exp_f32 v213, v213
    v_exp_f32 v214, v214
    v_exp_f32 v215, v215
    v_exp_f32 v220, v220
    v_exp_f32 v221, v221
    v_exp_f32 v222, v222
    v_exp_f32 v223, v223
    s_nop 0
    v_mul_f32 v239, v239, v245
    v_add_f32 v239, v239, v196
    v_add_f32 v239, v239, v197
    v_add_f32 v239, v239, v198
    v_add_f32 v239, v239, v199
    v_add_f32 v239, v239, v204
    v_add_f32 v239, v239, v205
    v_add_f32 v239, v239, v206
    v_add_f32 v239, v239, v207
    v_add_f32 v239, v239, v212
    v_add_f32 v239, v239, v213
    v_add_f32 v239, v239, v214
    v_add_f32 v239, v239, v215
    v_add_f32 v239, v239, v220
    v_add_f32 v239, v239, v221
    v_add_f32 v239, v239, v222
    v_add_f32 v239, v239, v223
    s_nop 1
    v_mul_f32_dpp v224, v244, v224 quad_perm:[0,0,2,2] row_mask:0xf bank_mask:0xf
    v_mul_f32_dpp v225, v244, v225 quad_perm:[1,1,3,3] row_mask:0xf bank_mask:0xf
    v_mul_f32_dpp v226, v244, v226 quad_perm:[0,0,2,2] row_mask:0xf bank_mask:0xf
    v_mul_f32_dpp v227, v244, v227 quad_perm:[1,1,3,3] row_mask:0xf bank_mask:0xf
    v_mul_f32_dpp v228, v245, v228 quad_perm:[0,0,2,2] row_mask:0xf bank_mask:0xf
    v_mul_f32_dpp v229, v245, v229 quad_perm:[1,1,3,3] row_mask:0xf bank_mask:0xf
    v_mul_f32_dpp v230, v245, v230 quad_perm:[0,0,2,2] row_mask:0xf bank_mask:0xf
    v_mul_f32_dpp v231, v245, v231 quad_perm:[1,1,3,3] row_mask:0xf bank_mask:0xf
    s_waitcnt vmcnt(16)
    v_cvt_pk_bf16_f32 v252, v192, v192
    v_and_b32 v240, v252, v232
    v_and_b32 v241, v252, v233
    v_and_b32 v242, v252, v234
    v_and_b32 v243, v252, v235
    s_nop 1
    v_mfma_f32_16x16x32_bf16 v[224:227], v[240:243], v[128:131], v[224:227]
    v_cvt_pk_bf16_f32 v252, v196, v196
    v_and_b32 v244, v252, v232
    v_and_b32 v245, v252, v233
    v_and_b32 v246, v252, v234
    v_and_b32 v247, v252, v235
    s_nop 1
    v_mfma_f32_16x16x32_bf16 v[228:231], v[244:247], v[128:131], v[228:231]
    v_cvt_pk_bf16_f32 v252, v193, v193
    v_and_b32 v248, v252, v232
    v_and_b32 v249, v252, v233
    v_and_b32 v250, v252, v234
    v_and_b32 v251, v252, v235
    s_nop 1
    v_mfma_f32_16x16x32_bf16 v[224:227], v[248:251], v[132:135], v[224:227]
    v_cvt_pk_bf16_f32 v252, v197, v197
    v_and_b32 v240, v252, v232
    v_and_b32 v241, v252, v233
    v_and_b32 v242, v252, v234
    v_and_b32 v243, v252, v235
    s_nop 1
    v_mfma_f32_16x16x32_bf16 v[228:231], v[240:243], v[132:135], v[228:231]
    v_cvt_pk_bf16_f32 v252, v194, v194
    v_and_b32 v244, v252, v232
    v_and_b32 v245, v252, v233
    v_and_b32 v246, v252, v234
    v_and_b32 v247, v252, v235
    s_nop 1
    v_mfma_f32_16x16x32_bf16 v[224:227], v[244:247], v[136:139], v[224:227]
    v_cvt_pk_bf16_f32 v252, v198, v198
    v_and_b32 v248, v252, v232
    v_and_b32 v249, v252, v233
    v_and_b32 v250, v252, v234
    v_and_b32 v251, v252, v235
    s_nop 1
    v_mfma_f32_16x16x32_bf16 v[228:231], v[248:251], v[136:139], v[228:231]
    v_cvt_pk_bf16_f32 v252, v195, v195
    v_and_b32 v240, v252, v232
    v_and_b32 v241, v252, v233
    v_and_b32 v242, v252, v234
    v_and_b32 v243, v252, v235
    s_nop 1
    v_mfma_f32_16x16x32_bf16 v[224:227], v[240:243], v[140:143], v[224:227]
    v_cvt_pk_bf16_f32 v252, v199, v199
    v_and_b32 v244, v252, v232
    v_and_b32 v245, v252, v233
    v_and_b32 v246, v252, v234
    v_and_b32 v247, v252, v235
    s_nop 1
    v_mfma_f32_16x16x32_bf16 v[228:231], v[244:247], v[140:143], v[228:231]
    v_cvt_pk_bf16_f32 v252, v200, v200
    v_and_b32 v248, v252, v232
    v_and_b32 v249, v252, v233
    v_and_b32 v250, v252, v234
    v_and_b32 v251, v252, v235
    s_nop 1
    v_mfma_f32_16x16x32_bf16 v[224:227], v[248:251], v[144:147], v[224:227]
    v_cvt_pk_bf16_f32 v252, v204, v204
    v_and_b32 v240, v252, v232
    v_and_b32 v241, v252, v233
    v_and_b32 v242, v252, v234
    v_and_b32 v243, v252, v235
    s_nop 1
    v_mfma_f32_16x16x32_bf16 v[228:231], v[240:243], v[144:147], v[228:231]
    v_cvt_pk_bf16_f32 v252, v201, v201
    v_and_b32 v244, v252, v232
    v_and_b32 v245, v252, v233
    v_and_b32 v246, v252, v234
    v_and_b32 v247, v252, v235
    s_nop 1
    v_mfma_f32_16x16x32_bf16 v[224:227], v[244:247], v[148:151], v[224:227]
    v_cvt_pk_bf16_f32 v252, v205, v205
    v_and_b32 v248, v252, v232
    v_and_b32 v249, v252, v233
    v_and_b32 v250, v252, v234
    v_and_b32 v251, v252, v235
    s_nop 1
    v_mfma_f32_16x16x32_bf16 v[228:231], v[248:251], v[148:151], v[228:231]
    v_cvt_pk_bf16_f32 v252, v202, v202
    v_and_b32 v240, v252, v232
    v_and_b32 v241, v252, v233
    v_and_b32 v242, v252, v234
    v_and_b32 v243, v252, v235
    s_nop 1
    v_mfma_f32_16x16x32_bf16 v[224:227], v[240:243], v[152:155], v[224:227]
    v_cvt_pk_bf16_f32 v252, v206, v206
    v_and_b32 v244, v252, v232
    v_and_b32 v245, v252, v233
    v_and_b32 v246, v252, v234
    v_and_b32 v247, v252, v235
    s_nop 1
    v_mfma_f32_16x16x32_bf16 v[228:231], v[244:247], v[152:155], v[228:231]
    v_cvt_pk_bf16_f32 v252, v203, v203
    v_and_b32 v248, v252, v232
    v_and_b32 v249, v252, v233
    v_and_b32 v250, v252, v234
    v_and_b32 v251, v252, v235
    s_nop 1
    v_mfma_f32_16x16x32_bf16 v[224:227], v[248:251], v[156:159], v[224:227]
    v_cvt_pk_bf16_f32 v252, v207, v207
    v_and_b32 v240, v252, v232
    v_and_b32 v241, v252, v233
    v_and_b32 v242, v252, v234
    v_and_b32 v243, v252, v235
    s_nop 1
    v_mfma_f32_16x16x32_bf16 v[228:231], v[240:243], v[156:159], v[228:231]
    v_cvt_pk_bf16_f32 v252, v208, v208
    v_and_b32 v244, v252, v232
    v_and_b32 v245, v252, v233
    v_and_b32 v246, v252, v234
    v_and_b32 v247, v252, v235
    s_nop 1
    v_mfma_f32_16x16x32_bf16 v[224:227], v[244:247], v[160:163], v[224:227]
    v_cvt_pk_bf16_f32 v252, v212, v212
    v_and_b32 v248, v252, v232
    v_and_b32 v249, v252, v233
    v_and_b32 v250, v252, v234
    v_and_b32 v251, v252, v235
    s_nop 1
    v_mfma_f32_16x16x32_bf16 v[228:231], v[248:251], v[160:163], v[228:231]
    v_cvt_pk_bf16_f32 v252, v209, v209
    v_and_b32 v240, v252, v232
    v_and_b32 v241, v252, v233
    v_and_b32 v242, v252, v234
    v_and_b32 v243, v252, v235
    s_nop 1
    v_mfma_f32_16x16x32_bf16 v[224:227], v[240:243], v[164:167], v[224:227]
    v_cvt_pk_bf16_f32 v252, v213, v213
    v_and_b32 v244, v252, v232
    v_and_b32 v245, v252, v233
    v_and_b32 v246, v252, v234
    v_and_b32 v247, v252, v235
    s_nop 1
    v_mfma_f32_16x16x32_bf16 v[228:231], v[244:247], v[164:167], v[228:231]
    v_cvt_pk_bf16_f32 v252, v210, v210
    v_and_b32 v248, v252, v232
    v_and_b32 v249, v252, v233
    v_and_b32 v250, v252, v234
    v_and_b32 v251, v252, v235
    s_nop 1
    v_mfma_f32_16x16x32_bf16 v[224:227], v[248:251], v[168:171], v[224:227]
    v_cvt_pk_bf16_f32 v252, v214, v214
    v_and_b32 v240, v252, v232
    v_and_b32 v241, v252, v233
    v_and_b32 v242, v252, v234
    v_and_b32 v243, v252, v235
    s_nop 1
    v_mfma_f32_16x16x32_bf16 v[228:231], v[240:243], v[168:171], v[228:231]
    v_cvt_pk_bf16_f32 v252, v211, v211
    v_and_b32 v244, v252, v232
    v_and_b32 v245, v252, v233
    v_and_b32 v246, v252, v234
    v_and_b32 v247, v252, v235
    s_nop 1
    v_mfma_f32_16x16x32_bf16 v[224:227], v[244:247], v[172:175], v[224:227]
    v_cvt_pk_bf16_f32 v252, v215, v215
    v_and_b32 v248, v252, v232
    v_and_b32 v249, v252, v233
    v_and_b32 v250, v252, v234
    v_and_b32 v251, v252, v235
    s_nop 1
    v_mfma_f32_16x16x32_bf16 v[228:231], v[248:251], v[172:175], v[228:231]
    v_cvt_pk_bf16_f32 v252, v216, v216
    v_and_b32 v240, v252, v232
    v_and_b32 v241, v252, v233
    v_and_b32 v242, v252, v234
    v_and_b32 v243, v252, v235
    s_nop 1
    v_mfma_f32_16x16x32_bf16 v[224:227], v[240:243], v[176:179], v[224:227]
    v_cvt_pk_bf16_f32 v252, v220, v220
    v_and_b32 v244, v252, v232
    v_and_b32 v245, v252, v233
    v_and_b32 v246, v252, v234
    v_and_b32 v247, v252, v235
    s_nop 1
    v_mfma_f32_16x16x32_bf16 v[228:231], v[244:247], v[176:179], v[228:231]
    v_cvt_pk_bf16_f32 v252, v217, v217
    v_and_b32 v248, v252, v232
    v_and_b32 v249, v252, v233
    v_and_b32 v250, v252, v234
    v_and_b32 v251, v252, v235
    s_nop 1
    v_mfma_f32_16x16x32_bf16 v[224:227], v[248:251], v[180:183], v[224:227]
    v_cvt_pk_bf16_f32 v252, v221, v221
    v_and_b32 v240, v252, v232
    v_and_b32 v241, v252, v233
    v_and_b32 v242, v252, v234
    v_and_b32 v243, v252, v235
    s_nop 1
    v_mfma_f32_16x16x32_bf16 v[228:231], v[240:243], v[180:183], v[228:231]
    v_cvt_pk_bf16_f32 v252, v218, v218
    v_and_b32 v244, v252, v232
    v_and_b32 v245, v252, v233
    v_and_b32 v246, v252, v234
    v_and_b32 v247, v252, v235
    s_nop 1
    v_mfma_f32_16x16x32_bf16 v[224:227], v[244:247], v[184:187], v[224:227]
    v_cvt_pk_bf16_f32 v252, v222, v222
    v_and_b32 v248, v252, v232
    v_and_b32 v249, v252, v233
    v_and_b32 v250, v252, v234
    v_and_b32 v251, v252, v235
    s_nop 1
    v_mfma_f32_16x16x32_bf16 v[228:231], v[248:251], v[184:187], v[228:231]
    v_cvt_pk_bf16_f32 v252, v219, v219
    v_and_b32 v240, v252, v232
    v_and_b32 v241, v252, v233
    v_and_b32 v242, v252, v234
    v_and_b32 v243, v252, v235
    s_nop 1
    v_mfma_f32_16x16x32_bf16 v[224:227], v[240:243], v[188:191], v[224:227]
    v_cvt_pk_bf16_f32 v252, v223, v223
    v_and_b32 v244, v252, v232
    v_and_b32 v245, v252, v233
    v_and_b32 v246, v252, v234
    v_and_b32 v247, v252, v235
    s_nop 1
    v_mfma_f32_16x16x32_bf16 v[228:231], v[244:247], v[188:191], v[228:231]
    s_add_u32 s20, s18, 49152
    buffer_load_dwordx4 v[128:131], v7, s[8:11], s20 offen offset:0 nt
    buffer_load_dwordx4 v[132:135], v7, s[8:11], s20 offen offset:256 nt
    buffer_load_dwordx4 v[136:139], v7, s[8:11], s20 offen offset:512 nt
    buffer_load_dwordx4 v[140:143], v7, s[8:11], s20 offen offset:768 nt
    s_add_u32 s20, s18, 53248
    buffer_load_dwordx4 v[144:147], v7, s[8:11], s20 offen offset:0 nt
    buffer_load_dwordx4 v[148:151], v7, s[8:11], s20 offen offset:256 nt
    buffer_load_dwordx4 v[152:155], v7, s[8:11], s20 offen offset:512 nt
    buffer_load_dwordx4 v[156:159], v7, s[8:11], s20 offen offset:768 nt
    s_add_u32 s20, s18, 57344
    buffer_load_dwordx4 v[160:163], v7, s[8:11], s20 offen offset:0 nt
    buffer_load_dwordx4 v[164:167], v7, s[8:11], s20 offen offset:256 nt
    buffer_load_dwordx4 v[168:171], v7, s[8:11], s20 offen offset:512 nt
    buffer_load_dwordx4 v[172:175], v7, s[8:11], s20 offen offset:768 nt
    s_add_u32 s20, s18, 61440
    buffer_load_dwordx4 v[176:179], v7, s[8:11], s20 offen offset:0 nt
    buffer_load_dwordx4 v[180:183], v7, s[8:11], s20 offen offset:256 nt
    buffer_load_dwordx4 v[184:187], v7, s[8:11], s20 offen offset:512 nt
    buffer_load_dwordx4 v[188:191], v7, s[8:11], s20 offen offset:768 nt
    s_nop 7
    s_nop 1
    s_waitcnt vmcnt(16)
    v_mfma_f32_16x16x32_bf16 v[192:195], v[64:67], v[16:19], 0
    v_mfma_f32_16x16x32_bf16 v[192:195], v[68:71], v[20:23], v[192:195]
    v_mfma_f32_16x16x32_bf16 v[192:195], v[72:75], v[24:27], v[192:195]
    v_mfma_f32_16x16x32_bf16 v[192:195], v[76:79], v[28:31], v[192:195]
    v_mfma_f32_16x16x32_bf16 v[196:199], v[64:67], v[32:35], 0
    v_mfma_f32_16x16x32_bf16 v[196:199], v[68:71], v[36:39], v[196:199]
    v_mfma_f32_16x16x32_bf16 v[196:199], v[72:75], v[40:43], v[196:199]
    v_mfma_f32_16x16x32_bf16 v[196:199], v[76:79], v[44:47], v[196:199]
    v_mfma_f32_16x16x32_bf16 v[200:203], v[80:83], v[16:19], 0
    v_mfma_f32_16x16x32_bf16 v[200:203], v[84:87], v[20:23], v[200:203]
    v_mfma_f32_16x16x32_bf16 v[200:203], v[88:91], v[24:27], v[200:203]
    v_mfma_f32_16x16x32_bf16 v[200:203], v[92:95], v[28:31], v[200:203]
    v_mfma_f32_16x16x32_bf16 v[204:207], v[80:83], v[32:35], 0
    v_mfma_f32_16x16x32_bf16 v[204:207], v[84:87], v[36:39], v[204:207]
    v_mfma_f32_16x16x32_bf16 v[204:207], v[88:91], v[40:43], v[204:207]
    v_mfma_f32_16x16x32_bf16 v[204:207], v[92:95], v[44:47], v[204:207]
    v_mfma_f32_16x16x32_bf16 v[208:211], v[96:99], v[16:19], 0
    v_mfma_f32_16x16x32_bf16 v[208:211], v[100:103], v[20:23], v[208:211]
    v_mfma_f32_16x16x32_bf16 v[208:211], v[104:107], v[24:27], v[208:211]
    v_mfma_f32_16x16x32_bf16 v[208:211], v[108:111], v[28:31], v[208:211]
    v_mfma_f32_16x16x32_bf16 v[212:215], v[96:99], v[32:35], 0
    v_mfma_f32_16x16x32_bf16 v[212:215], v[100:103], v[36:39], v[212:215]
    v_mfma_f32_16x16x32_bf16 v[212:215], v[104:107], v[40:43], v[212:215]
    v_mfma_f32_16x16x32_bf16 v[212:215], v[108:111], v[44:47], v[212:215]
    v_mfma_f32_16x16x32_bf16 v[216:219], v[112:115], v[16:19], 0
    v_mfma_f32_16x16x32_bf16 v[216:219], v[116:119], v[20:23], v[216:219]
    v_mfma_f32_16x16x32_bf16 v[216:219], v[120:123], v[24:27], v[216:219]
    v_mfma_f32_16x16x32_bf16 v[216:219], v[124:127], v[28:31], v[216:219]
    v_mfma_f32_16x16x32_bf16 v[220:223], v[112:115], v[32:35], 0
    v_mfma_f32_16x16x32_bf16 v[220:223], v[116:119], v[36:39], v[220:223]
    v_mfma_f32_16x16x32_bf16 v[220:223], v[120:123], v[40:43], v[220:223]
    v_mfma_f32_16x16x32_bf16 v[220:223], v[124:127], v[44:47], v[220:223]
    s_nop 7
    s_nop 1
    v_max3_f32 v240, v192, v193, v194
    v_max3_f32 v240, v240, v195, v200
    v_max3_f32 v240, v240, v201, v202
    v_max3_f32 v240, v240, v203, v208
    v_max3_f32 v240, v240, v209, v210
    v_max3_f32 v240, v240, v211, v216
    v_max3_f32 v240, v240, v217, v218
    v_max3_f32 v240, v240, v219, v236
    v_mov_b32 v242, v240
    s_nop 1
    v_permlane16_swap_b32 v242, v240
    s_nop 1
    v_max_f32 v240, v240, v242
    v_mov_b32 v242, v240
    s_nop 1
    v_permlane32_swap_b32 v242, v240
    s_nop 1
    v_max_f32 v240, v240, v242
    v_sub_f32 v243, v236, v240
    v_mul_f32 v243, 0x3e0293ee, v243
    v_exp_f32 v244, v243
    v_mov_b32 v236, v240
    v_mul_f32 v243, 0x3e0293ee, v240
    s_mov_b32 s21, 0x3e0293ee
    v_fma_f32 v192, v192, s21, -v243
    v_fma_f32 v193, v193, s21, -v243
    v_fma_f32 v194, v194, s21, -v243
    v_fma_f32 v195, v195, s21, -v243
    v_fma_f32 v200, v200, s21, -v243
    v_fma_f32 v201, v201, s21, -v243
    v_fma_f32 v202, v202, s21, -v243
    v_fma_f32 v203, v203, s21, -v243
    v_fma_f32 v208, v208, s21, -v243
    v_fma_f32 v209, v209, s21, -v243
    v_fma_f32 v210, v210, s21, -v243
    v_fma_f32 v211, v211, s21, -v243
    v_fma_f32 v216, v216, s21, -v243
    v_fma_f32 v217, v217, s21, -v243
    v_fma_f32 v218, v218, s21, -v243
    v_fma_f32 v219, v219, s21, -v243
    v_exp_f32 v192, v192
    v_exp_f32 v193, v193
    v_exp_f32 v194, v194
    v_exp_f32 v195, v195
    v_exp_f32 v200, v200
    v_exp_f32 v201, v201
    v_exp_f32 v202, v202
    v_exp_f32 v203, v203
    v_exp_f32 v208, v208
    v_exp_f32 v209, v209
    v_exp_f32 v210, v210
    v_exp_f32 v211, v211
    v_exp_f32 v216, v216
    v_exp_f32 v217, v217
    v_exp_f32 v218, v218
    v_exp_f32 v219, v219
    s_nop 0
    v_mul_f32 v238, v238, v244
    v_add_f32 v238, v238, v192
    v_add_f32 v238, v238, v193
    v_add_f32 v238, v238, v194
    v_add_f32 v238, v238, v195
    v_add_f32 v238, v238, v200
    v_add_f32 v238, v238, v201
    v_add_f32 v238, v238, v202
    v_add_f32 v238, v238, v203
    v_add_f32 v238, v238, v208
    v_add_f32 v238, v238, v209
    v_add_f32 v238, v238, v210
    v_add_f32 v238, v238, v211
    v_add_f32 v238, v238, v216
    v_add_f32 v238, v238, v217
    v_add_f32 v238, v238, v218
    v_add_f32 v238, v238, v219
    v_max3_f32 v241, v196, v197, v198
    v_max3_f32 v241, v241, v199, v204
    v_max3_f32 v241, v241, v205, v206
    v_max3_f32 v241, v241, v207, v212
    v_max3_f32 v241, v241, v213, v214
    v_max3_f32 v241, v241, v215, v220
    v_max3_f32 v241, v241, v221, v222
    v_max3_f32 v241, v241, v223, v237
    v_mov_b32 v242, v241
    s_nop 1
    v_permlane16_swap_b32 v242, v241
    s_nop 1
    v_max_f32 v241, v241, v242
    v_mov_b32 v242, v241
    s_nop 1
    v_permlane32_swap_b32 v242, v241
    s_nop 1
    v_max_f32 v241, v241, v242
    v_sub_f32 v243, v237, v241
    v_mul_f32 v243, 0x3e0293ee, v243
    v_exp_f32 v245, v243
    v_mov_b32 v237, v241
    v_mul_f32 v243, 0x3e0293ee, v241
    s_mov_b32 s21, 0x3e0293ee
    v_fma_f32 v196, v196, s21, -v243
    v_fma_f32 v197, v197, s21, -v243
    v_fma_f32 v198, v198, s21, -v243
    v_fma_f32 v199, v199, s21, -v243
    v_fma_f32 v204, v204, s21, -v243
    v_fma_f32 v205, v205, s21, -v243
    v_fma_f32 v206, v206, s21, -v243
    v_fma_f32 v207, v207, s21, -v243
    v_fma_f32 v212, v212, s21, -v243
    v_fma_f32 v213, v213, s21, -v243
    v_fma_f32 v214, v214, s21, -v243
    v_fma_f32 v215, v215, s21, -v243
    v_fma_f32 v220, v220, s21, -v243
    v_fma_f32 v221, v221, s21, -v243
    v_fma_f32 v222, v222, s21, -v243
    v_fma_f32 v223, v223, s21, -v243
    v_exp_f32 v196, v196
    v_exp_f32 v197, v197
    v_exp_f32 v198, v198
    v_exp_f32 v199, v199
    v_exp_f32 v204, v204
    v_exp_f32 v205, v205
    v_exp_f32 v206, v206
    v_exp_f32 v207, v207
    v_exp_f32 v212, v212
    v_exp_f32 v213, v213
    v_exp_f32 v214, v214
    v_exp_f32 v215, v215
    v_exp_f32 v220, v220
    v_exp_f32 v221, v221
    v_exp_f32 v222, v222
    v_exp_f32 v223, v223
    s_nop 0
    v_mul_f32 v239, v239, v245
    v_add_f32 v239, v239, v196
    v_add_f32 v239, v239, v197
    v_add_f32 v239, v239, v198
    v_add_f32 v239, v239, v199
    v_add_f32 v239, v239, v204
    v_add_f32 v239, v239, v205
    v_add_f32 v239, v239, v206
    v_add_f32 v239, v239, v207
    v_add_f32 v239, v239, v212
    v_add_f32 v239, v239, v213
    v_add_f32 v239, v239, v214
    v_add_f32 v239, v239, v215
    v_add_f32 v239, v239, v220
    v_add_f32 v239, v239, v221
    v_add_f32 v239, v239, v222
    v_add_f32 v239, v239, v223
    s_nop 1
    v_mul_f32_dpp v224, v244, v224 quad_perm:[0,0,2,2] row_mask:0xf bank_mask:0xf
    v_mul_f32_dpp v225, v244, v225 quad_perm:[1,1,3,3] row_mask:0xf bank_mask:0xf
    v_mul_f32_dpp v226, v244, v226 quad_perm:[0,0,2,2] row_mask:0xf bank_mask:0xf
    v_mul_f32_dpp v227, v244, v227 quad_perm:[1,1,3,3] row_mask:0xf bank_mask:0xf
    v_mul_f32_dpp v228, v245, v228 quad_perm:[0,0,2,2] row_mask:0xf bank_mask:0xf
    v_mul_f32_dpp v229, v245, v229 quad_perm:[1,1,3,3] row_mask:0xf bank_mask:0xf
    v_mul_f32_dpp v230, v245, v230 quad_perm:[0,0,2,2] row_mask:0xf bank_mask:0xf
    v_mul_f32_dpp v231, v245, v231 quad_perm:[1,1,3,3] row_mask:0xf bank_mask:0xf
    s_waitcnt vmcnt(0)
    v_cvt_pk_bf16_f32 v252, v192, v192
    v_and_b32 v240, v252, v232
    v_and_b32 v241, v252, v233
    v_and_b32 v242, v252, v234
    v_and_b32 v243, v252, v235
    s_nop 1
    v_mfma_f32_16x16x32_bf16 v[224:227], v[240:243], v[128:131], v[224:227]
    v_cvt_pk_bf16_f32 v252, v196, v196
    v_and_b32 v244, v252, v232
    v_and_b32 v245, v252, v233
    v_and_b32 v246, v252, v234
    v_and_b32 v247, v252, v235
    s_nop 1
    v_mfma_f32_16x16x32_bf16 v[228:231], v[244:247], v[128:131], v[228:231]
    v_cvt_pk_bf16_f32 v252, v193, v193
    v_and_b32 v248, v252, v232
    v_and_b32 v249, v252, v233
    v_and_b32 v250, v252, v234
    v_and_b32 v251, v252, v235
    s_nop 1
    v_mfma_f32_16x16x32_bf16 v[224:227], v[248:251], v[132:135], v[224:227]
    v_cvt_pk_bf16_f32 v252, v197, v197
    v_and_b32 v240, v252, v232
    v_and_b32 v241, v252, v233
    v_and_b32 v242, v252, v234
    v_and_b32 v243, v252, v235
    s_nop 1
    v_mfma_f32_16x16x32_bf16 v[228:231], v[240:243], v[132:135], v[228:231]
    v_cvt_pk_bf16_f32 v252, v194, v194
    v_and_b32 v244, v252, v232
    v_and_b32 v245, v252, v233
    v_and_b32 v246, v252, v234
    v_and_b32 v247, v252, v235
    s_nop 1
    v_mfma_f32_16x16x32_bf16 v[224:227], v[244:247], v[136:139], v[224:227]
    v_cvt_pk_bf16_f32 v252, v198, v198
    v_and_b32 v248, v252, v232
    v_and_b32 v249, v252, v233
    v_and_b32 v250, v252, v234
    v_and_b32 v251, v252, v235
    s_nop 1
    v_mfma_f32_16x16x32_bf16 v[228:231], v[248:251], v[136:139], v[228:231]
    v_cvt_pk_bf16_f32 v252, v195, v195
    v_and_b32 v240, v252, v232
    v_and_b32 v241, v252, v233
    v_and_b32 v242, v252, v234
    v_and_b32 v243, v252, v235
    s_nop 1
    v_mfma_f32_16x16x32_bf16 v[224:227], v[240:243], v[140:143], v[224:227]
    v_cvt_pk_bf16_f32 v252, v199, v199
    v_and_b32 v244, v252, v232
    v_and_b32 v245, v252, v233
    v_and_b32 v246, v252, v234
    v_and_b32 v247, v252, v235
    s_nop 1
    v_mfma_f32_16x16x32_bf16 v[228:231], v[244:247], v[140:143], v[228:231]
    v_cvt_pk_bf16_f32 v252, v200, v200
    v_and_b32 v248, v252, v232
    v_and_b32 v249, v252, v233
    v_and_b32 v250, v252, v234
    v_and_b32 v251, v252, v235
    s_nop 1
    v_mfma_f32_16x16x32_bf16 v[224:227], v[248:251], v[144:147], v[224:227]
    v_cvt_pk_bf16_f32 v252, v204, v204
    v_and_b32 v240, v252, v232
    v_and_b32 v241, v252, v233
    v_and_b32 v242, v252, v234
    v_and_b32 v243, v252, v235
    s_nop 1
    v_mfma_f32_16x16x32_bf16 v[228:231], v[240:243], v[144:147], v[228:231]
    v_cvt_pk_bf16_f32 v252, v201, v201
    v_and_b32 v244, v252, v232
    v_and_b32 v245, v252, v233
    v_and_b32 v246, v252, v234
    v_and_b32 v247, v252, v235
    s_nop 1
    v_mfma_f32_16x16x32_bf16 v[224:227], v[244:247], v[148:151], v[224:227]
    v_cvt_pk_bf16_f32 v252, v205, v205
    v_and_b32 v248, v252, v232
    v_and_b32 v249, v252, v233
    v_and_b32 v250, v252, v234
    v_and_b32 v251, v252, v235
    s_nop 1
    v_mfma_f32_16x16x32_bf16 v[228:231], v[248:251], v[148:151], v[228:231]
    v_cvt_pk_bf16_f32 v252, v202, v202
    v_and_b32 v240, v252, v232
    v_and_b32 v241, v252, v233
    v_and_b32 v242, v252, v234
    v_and_b32 v243, v252, v235
    s_nop 1
    v_mfma_f32_16x16x32_bf16 v[224:227], v[240:243], v[152:155], v[224:227]
    v_cvt_pk_bf16_f32 v252, v206, v206
    v_and_b32 v244, v252, v232
    v_and_b32 v245, v252, v233
    v_and_b32 v246, v252, v234
    v_and_b32 v247, v252, v235
    s_nop 1
    v_mfma_f32_16x16x32_bf16 v[228:231], v[244:247], v[152:155], v[228:231]
    v_cvt_pk_bf16_f32 v252, v203, v203
    v_and_b32 v248, v252, v232
    v_and_b32 v249, v252, v233
    v_and_b32 v250, v252, v234
    v_and_b32 v251, v252, v235
    s_nop 1
    v_mfma_f32_16x16x32_bf16 v[224:227], v[248:251], v[156:159], v[224:227]
    v_cvt_pk_bf16_f32 v252, v207, v207
    v_and_b32 v240, v252, v232
    v_and_b32 v241, v252, v233
    v_and_b32 v242, v252, v234
    v_and_b32 v243, v252, v235
    s_nop 1
    v_mfma_f32_16x16x32_bf16 v[228:231], v[240:243], v[156:159], v[228:231]
    v_cvt_pk_bf16_f32 v252, v208, v208
    v_and_b32 v244, v252, v232
    v_and_b32 v245, v252, v233
    v_and_b32 v246, v252, v234
    v_and_b32 v247, v252, v235
    s_nop 1
    v_mfma_f32_16x16x32_bf16 v[224:227], v[244:247], v[160:163], v[224:227]
    v_cvt_pk_bf16_f32 v252, v212, v212
    v_and_b32 v248, v252, v232
    v_and_b32 v249, v252, v233
    v_and_b32 v250, v252, v234
    v_and_b32 v251, v252, v235
    s_nop 1
    v_mfma_f32_16x16x32_bf16 v[228:231], v[248:251], v[160:163], v[228:231]
    v_cvt_pk_bf16_f32 v252, v209, v209
    v_and_b32 v240, v252, v232
    v_and_b32 v241, v252, v233
    v_and_b32 v242, v252, v234
    v_and_b32 v243, v252, v235
    s_nop 1
    v_mfma_f32_16x16x32_bf16 v[224:227], v[240:243], v[164:167], v[224:227]
    v_cvt_pk_bf16_f32 v252, v213, v213
    v_and_b32 v244, v252, v232
    v_and_b32 v245, v252, v233
    v_and_b32 v246, v252, v234
    v_and_b32 v247, v252, v235
    s_nop 1
    v_mfma_f32_16x16x32_bf16 v[228:231], v[244:247], v[164:167], v[228:231]
    v_cvt_pk_bf16_f32 v252, v210, v210
    v_and_b32 v248, v252, v232
    v_and_b32 v249, v252, v233
    v_and_b32 v250, v252, v234
    v_and_b32 v251, v252, v235
    s_nop 1
    v_mfma_f32_16x16x32_bf16 v[224:227], v[248:251], v[168:171], v[224:227]
    v_cvt_pk_bf16_f32 v252, v214, v214
    v_and_b32 v240, v252, v232
    v_and_b32 v241, v252, v233
    v_and_b32 v242, v252, v234
    v_and_b32 v243, v252, v235
    s_nop 1
    v_mfma_f32_16x16x32_bf16 v[228:231], v[240:243], v[168:171], v[228:231]
    v_cvt_pk_bf16_f32 v252, v211, v211
    v_and_b32 v244, v252, v232
    v_and_b32 v245, v252, v233
    v_and_b32 v246, v252, v234
    v_and_b32 v247, v252, v235
    s_nop 1
    v_mfma_f32_16x16x32_bf16 v[224:227], v[244:247], v[172:175], v[224:227]
    v_cvt_pk_bf16_f32 v252, v215, v215
    v_and_b32 v248, v252, v232
    v_and_b32 v249, v252, v233
    v_and_b32 v250, v252, v234
    v_and_b32 v251, v252, v235
    s_nop 1
    v_mfma_f32_16x16x32_bf16 v[228:231], v[248:251], v[172:175], v[228:231]
    v_cvt_pk_bf16_f32 v252, v216, v216
    v_and_b32 v240, v252, v232
    v_and_b32 v241, v252, v233
    v_and_b32 v242, v252, v234
    v_and_b32 v243, v252, v235
    s_nop 1
    v_mfma_f32_16x16x32_bf16 v[224:227], v[240:243], v[176:179], v[224:227]
    v_cvt_pk_bf16_f32 v252, v220, v220
    v_and_b32 v244, v252, v232
    v_and_b32 v245, v252, v233
    v_and_b32 v246, v252, v234
    v_and_b32 v247, v252, v235
    s_nop 1
    v_mfma_f32_16x16x32_bf16 v[228:231], v[244:247], v[176:179], v[228:231]
    v_cvt_pk_bf16_f32 v252, v217, v217
    v_and_b32 v248, v252, v232
    v_and_b32 v249, v252, v233
    v_and_b32 v250, v252, v234
    v_and_b32 v251, v252, v235
    s_nop 1
    v_mfma_f32_16x16x32_bf16 v[224:227], v[248:251], v[180:183], v[224:227]
    v_cvt_pk_bf16_f32 v252, v221, v221
    v_and_b32 v240, v252, v232
    v_and_b32 v241, v252, v233
    v_and_b32 v242, v252, v234
    v_and_b32 v243, v252, v235
    s_nop 1
    v_mfma_f32_16x16x32_bf16 v[228:231], v[240:243], v[180:183], v[228:231]
    v_cvt_pk_bf16_f32 v252, v218, v218
    v_and_b32 v244, v252, v232
    v_and_b32 v245, v252, v233
    v_and_b32 v246, v252, v234
    v_and_b32 v247, v252, v235
    s_nop 1
    v_mfma_f32_16x16x32_bf16 v[224:227], v[244:247], v[184:187], v[224:227]
    v_cvt_pk_bf16_f32 v252, v222, v222
    v_and_b32 v248, v252, v232
    v_and_b32 v249, v252, v233
    v_and_b32 v250, v252, v234
    v_and_b32 v251, v252, v235
    s_nop 1
    v_mfma_f32_16x16x32_bf16 v[228:231], v[248:251], v[184:187], v[228:231]
    v_cvt_pk_bf16_f32 v252, v219, v219
    v_and_b32 v240, v252, v232
    v_and_b32 v241, v252, v233
    v_and_b32 v242, v252, v234
    v_and_b32 v243, v252, v235
    s_nop 1
    v_mfma_f32_16x16x32_bf16 v[224:227], v[240:243], v[188:191], v[224:227]
    v_cvt_pk_bf16_f32 v252, v223, v223
    v_and_b32 v244, v252, v232
    v_and_b32 v245, v252, v233
    v_and_b32 v246, v252, v234
    v_and_b32 v247, v252, v235
    s_nop 1
    v_mfma_f32_16x16x32_bf16 v[228:231], v[244:247], v[188:191], v[228:231]
    s_nop 7
    s_nop 1
    v_mov_b32 v242, v238
    s_nop 1
    v_permlane16_swap_b32 v242, v238
    s_nop 1
    v_add_f32 v238, v238, v242
    v_mov_b32 v242, v238
    s_nop 1
    v_permlane32_swap_b32 v242, v238
    s_nop 1
    v_add_f32 v238, v238, v242
    v_mov_b32 v242, v239
    s_nop 1
    v_permlane16_swap_b32 v242, v239
    s_nop 1
    v_add_f32 v239, v239, v242
    v_mov_b32 v242, v239
    s_nop 1
    v_permlane32_swap_b32 v242, v239
    s_nop 1
    v_add_f32 v239, v239, v242
    v_lshlrev_b32 v9, 11, v1
    v_lshl_add_u32 v9, v3, 5, v9
    v_lshl_add_u32 v9, v4, 3, v9
    ds_write_b32 v9, v224 offset:4096
    ds_write_b32 v9, v225 offset:4608
    ds_write_b32 v9, v226 offset:4100
    ds_write_b32 v9, v227 offset:4612
    ds_write_b32 v9, v228 offset:5120
    ds_write_b32 v9, v229 offset:5632
    ds_write_b32 v9, v230 offset:5124
    ds_write_b32 v9, v231 offset:5636
    v_lshlrev_b32 v10, 5, v1
    v_lshl_add_u32 v10, v2, 2, v10
    v_cmp_gt_u32 vcc, 2, v2
    s_and_saveexec_b64 s[22:23], vcc
    ds_write_b32 v10, v236 offset:1024
    ds_write_b32 v10, v238 offset:1040
    ds_write_b32 v10, v237 offset:1032
    ds_write_b32 v10, v239 offset:1048
    s_mov_b64 exec, s[22:23]
    s_waitcnt lgkmcnt(0)
    s_barrier
    v_lshrrev_b32 v9, 7, v0
    v_lshlrev_b32 v10, 2, v9
    v_lshlrev_b32 v11, 2, v0
    ds_read_b32 v16, v10 offset:1024
    ds_read_b32 v24, v10 offset:1040
    ds_read_b32 v32, v11 offset:4096
    ds_read_b32 v17, v10 offset:1056
    ds_read_b32 v25, v10 offset:1072
    ds_read_b32 v33, v11 offset:6144
    ds_read_b32 v18, v10 offset:1088
    ds_read_b32 v26, v10 offset:1104
    ds_read_b32 v34, v11 offset:8192
    ds_read_b32 v19, v10 offset:1120
    ds_read_b32 v27, v10 offset:1136
    ds_read_b32 v35, v11 offset:10240
    ds_read_b32 v20, v10 offset:1152
    ds_read_b32 v28, v10 offset:1168
    ds_read_b32 v36, v11 offset:12288
    ds_read_b32 v21, v10 offset:1184
    ds_read_b32 v29, v10 offset:1200
    ds_read_b32 v37, v11 offset:14336
    ds_read_b32 v22, v10 offset:1216
    ds_read_b32 v30, v10 offset:1232
    ds_read_b32 v38, v11 offset:16384
    ds_read_b32 v23, v10 offset:1248
    ds_read_b32 v31, v10 offset:1264
    ds_read_b32 v39, v11 offset:18432
    s_waitcnt lgkmcnt(0)
    v_max3_f32 v40, v16, v17, v18
    v_max3_f32 v40, v40, v19, v20
    v_max3_f32 v40, v40, v21, v22
    v_max_f32 v40, v40, v23
    v_mov_b32 v41, 0
    v_mov_b32 v42, 0
    v_sub_f32 v43, v16, v40
    v_mul_f32 v43, 0x3e0293ee, v43
    v_exp_f32 v43, v43
    s_nop 0
    v_fmac_f32 v41, v24, v43
    v_fmac_f32 v42, v32, v43
    v_sub_f32 v43, v17, v40
    v_mul_f32 v43, 0x3e0293ee, v43
    v_exp_f32 v43, v43
    s_nop 0
    v_fmac_f32 v41, v25, v43
    v_fmac_f32 v42, v33, v43
    v_sub_f32 v43, v18, v40
    v_mul_f32 v43, 0x3e0293ee, v43
    v_exp_f32 v43, v43
    s_nop 0
    v_fmac_f32 v41, v26, v43
    v_fmac_f32 v42, v34, v43
    v_sub_f32 v43, v19, v40
    v_mul_f32 v43, 0x3e0293ee, v43
    v_exp_f32 v43, v43
    s_nop 0
    v_fmac_f32 v41, v27, v43
    v_fmac_f32 v42, v35, v43
    v_sub_f32 v43, v20, v40
    v_mul_f32 v43, 0x3e0293ee, v43
    v_exp_f32 v43, v43
    s_nop 0
    v_fmac_f32 v41, v28, v43
    v_fmac_f32 v42, v36, v43
    v_sub_f32 v43, v21, v40
    v_mul_f32 v43, 0x3e0293ee, v43
    v_exp_f32 v43, v43
    s_nop 0
    v_fmac_f32 v41, v29, v43
    v_fmac_f32 v42, v37, v43
    v_sub_f32 v43, v22, v40
    v_mul_f32 v43, 0x3e0293ee, v43
    v_exp_f32 v43, v43
    s_nop 0
    v_fmac_f32 v41, v30, v43
    v_fmac_f32 v42, v38, v43
    v_sub_f32 v43, v23, v40
    v_mul_f32 v43, 0x3e0293ee, v43
    v_exp_f32 v43, v43
    s_nop 0
    v_fmac_f32 v41, v31, v43
    v_fmac_f32 v42, v39, v43
    s_lshl_b32 s24, s2, 11
    v_add_u32 v11, s24, v11
    v_add_u32 v11, 262144, v11
    global_store_dword v11, v42, s[12:13]
    v_and_b32 v12, 127, v0
    v_cmp_eq_u32 vcc, 0, v12
    s_lshl_b32 s24, s2, 5
    v_lshl_add_u32 v12, v9, 2, s24
    v_add_u32 v12, 786432, v12
    s_and_saveexec_b64 s[22:23], vcc
    global_store_dword v12, v40, s[12:13]
    global_store_dword v12, v41, s[12:13] offset:16
K3_END:
    s_endpgm
.section .rodata,"a"
.p2align 6
.amdhsa_kernel k3_kernel
  .amdhsa_next_free_vgpr 256
  .amdhsa_next_free_sgpr 102
  .amdhsa_accum_offset 256
  .amdhsa_group_segment_fixed_size 0
  .amdhsa_kernarg_size 112
  .amdhsa_user_sgpr_count 2
  .amdhsa_user_sgpr_kernarg_segment_ptr 1
  .amdhsa_system_sgpr_workgroup_id_x 1
.end_amdhsa_kernel
.text
.globl k4_kernel
.p2align 8
.type k4_kernel,@function
k4_kernel:
    s_cmp_ge_u32 s2, 256
    s_cbranch_scc1 K4_END
    s_load_dwordx2 s[6:7], s[0:1], 32
    s_load_dwordx2 s[8:9], s[0:1], 104
    s_and_b32 s10, s2, 31
    s_lshr_b32 s11, s2, 5
    v_lshrrev_b32 v1, 3, v0
    v_and_b32 v2, 7, v0
    s_lshl_b32 s12, s10, 7
    v_lshl_add_u32 v3, v1, 2, s12
    v_lshlrev_b32 v4, 10, v3
    s_lshl_b32 s13, s11, 7
    v_lshl_add_u32 v5, v2, 4, s13
    v_add_u32 v4, v4, v5
    s_waitcnt lgkmcnt(0)
    global_load_dwordx4 v[8:11], v4, s[6:7]
    global_load_dwordx4 v[12:15], v4, s[6:7] offset:1024
    global_load_dwordx4 v[16:19], v4, s[6:7] offset:2048
    global_load_dwordx4 v[20:23], v4, s[6:7] offset:3072
    v_lshrrev_b32 v32, 7, v0
    v_and_b32 v33, 127, v0
    s_lshr_b32 s14, s10, 2
    s_and_b32 s15, s10, 3
    v_lshl_add_u32 v34, v32, 3, s14
    v_lshlrev_b32 v35, 9, v34
    s_lshl_b32 s16, s15, 2
    v_add_u32 v35, s16, v35
    v_add_u32 v35, 786432, v35
    v_lshlrev_b32 v36, 15, v34
    s_lshl_b32 s16, s15, 9
    v_lshl_add_u32 v36, v33, 2, v36
    v_add_u32 v36, s16, v36
    v_add_u32 v36, 262144, v36
    global_load_dword v64, v35, s[8:9] offset:0
    global_load_dword v80, v35, s[8:9] offset:16
    global_load_dword v65, v35, s[8:9] offset:32
    global_load_dword v81, v35, s[8:9] offset:48
    global_load_dword v66, v35, s[8:9] offset:64
    global_load_dword v82, v35, s[8:9] offset:80
    global_load_dword v67, v35, s[8:9] offset:96
    global_load_dword v83, v35, s[8:9] offset:112
    global_load_dword v68, v35, s[8:9] offset:128
    global_load_dword v84, v35, s[8:9] offset:144
    global_load_dword v69, v35, s[8:9] offset:160
    global_load_dword v85, v35, s[8:9] offset:176
    global_load_dword v70, v35, s[8:9] offset:192
    global_load_dword v86, v35, s[8:9] offset:208
    global_load_dword v71, v35, s[8:9] offset:224
    global_load_dword v87, v35, s[8:9] offset:240
    global_load_dword v72, v35, s[8:9] offset:256
    global_load_dword v88, v35, s[8:9] offset:272
    global_load_dword v73, v35, s[8:9] offset:288
    global_load_dword v89, v35, s[8:9] offset:304
    global_load_dword v74, v35, s[8:9] offset:320
    global_load_dword v90, v35, s[8:9] offset:336
    global_load_dword v75, v35, s[8:9] offset:352
    global_load_dword v91, v35, s[8:9] offset:368
    global_load_dword v76, v35, s[8:9] offset:384
    global_load_dword v92, v35, s[8:9] offset:400
    global_load_dword v77, v35, s[8:9] offset:416
    global_load_dword v93, v35, s[8:9] offset:432
    global_load_dword v78, v35, s[8:9] offset:448
    global_load_dword v94, v35, s[8:9] offset:464
    global_load_dword v79, v35, s[8:9] offset:480
    global_load_dword v95, v35, s[8:9] offset:496
    global_load_dword v96, v36, s[8:9]
    v_add_u32 v36, 0x800, v36
    global_load_dword v97, v36, s[8:9]
    v_add_u32 v36, 0x800, v36
    global_load_dword v98, v36, s[8:9]
    v_add_u32 v36, 0x800, v36
    global_load_dword v99, v36, s[8:9]
    v_add_u32 v36, 0x800, v36
    global_load_dword v100, v36, s[8:9]
    v_add_u32 v36, 0x800, v36
    global_load_dword v101, v36, s[8:9]
    v_add_u32 v36, 0x800, v36
    global_load_dword v102, v36, s[8:9]
    v_add_u32 v36, 0x800, v36
    global_load_dword v103, v36, s[8:9]
    v_add_u32 v36, 0x800, v36
    global_load_dword v104, v36, s[8:9]
    v_add_u32 v36, 0x800, v36
    global_load_dword v105, v36, s[8:9]
    v_add_u32 v36, 0x800, v36
    global_load_dword v106, v36, s[8:9]
    v_add_u32 v36, 0x800, v36
    global_load_dword v107, v36, s[8:9]
    v_add_u32 v36, 0x800, v36
    global_load_dword v108, v36, s[8:9]
    v_add_u32 v36, 0x800, v36
    global_load_dword v109, v36, s[8:9]
    v_add_u32 v36, 0x800, v36
    global_load_dword v110, v36, s[8:9]
    v_add_u32 v36, 0x800, v36
    global_load_dword v111, v36, s[8:9]
    v_add_u32 v36, 0x800, v36
    s_waitcnt vmcnt(0)
    v_max3_f32 v40, v64, v65, v66
    v_max3_f32 v40, v40, v67, v68
    v_max3_f32 v40, v40, v69, v70
    v_max3_f32 v40, v40, v71, v72
    v_max3_f32 v40, v40, v73, v74
    v_max3_f32 v40, v40, v75, v76
    v_max3_f32 v40, v40, v77, v78
    v_max_f32 v40, v40, v79
    v_mov_b32 v41, 0
    v_mov_b32 v42, 0
    v_sub_f32 v43, v64, v40
    v_mul_f32 v43, 0x3e0293ee, v43
    v_exp_f32 v43, v43
    s_nop 0
    v_fmac_f32 v41, v80, v43
    v_fmac_f32 v42, v96, v43
    v_sub_f32 v43, v65, v40
    v_mul_f32 v43, 0x3e0293ee, v43
    v_exp_f32 v43, v43
    s_nop 0
    v_fmac_f32 v41, v81, v43
    v_fmac_f32 v42, v97, v43
    v_sub_f32 v43, v66, v40
    v_mul_f32 v43, 0x3e0293ee, v43
    v_exp_f32 v43, v43
    s_nop 0
    v_fmac_f32 v41, v82, v43
    v_fmac_f32 v42, v98, v43
    v_sub_f32 v43, v67, v40
    v_mul_f32 v43, 0x3e0293ee, v43
    v_exp_f32 v43, v43
    s_nop 0
    v_fmac_f32 v41, v83, v43
    v_fmac_f32 v42, v99, v43
    v_sub_f32 v43, v68, v40
    v_mul_f32 v43, 0x3e0293ee, v43
    v_exp_f32 v43, v43
    s_nop 0
    v_fmac_f32 v41, v84, v43
    v_fmac_f32 v42, v100, v43
    v_sub_f32 v43, v69, v40
    v_mul_f32 v43, 0x3e0293ee, v43
    v_exp_f32 v43, v43
    s_nop 0
    v_fmac_f32 v41, v85, v43
    v_fmac_f32 v42, v101, v43
    v_sub_f32 v43, v70, v40
    v_mul_f32 v43, 0x3e0293ee, v43
    v_exp_f32 v43, v43
    s_nop 0
    v_fmac_f32 v41, v86, v43
    v_fmac_f32 v42, v102, v43
    v_sub_f32 v43, v71, v40
    v_mul_f32 v43, 0x3e0293ee, v43
    v_exp_f32 v43, v43
    s_nop 0
    v_fmac_f32 v41, v87, v43
    v_fmac_f32 v42, v103, v43
    v_sub_f32 v43, v72, v40
    v_mul_f32 v43, 0x3e0293ee, v43
    v_exp_f32 v43, v43
    s_nop 0
    v_fmac_f32 v41, v88, v43
    v_fmac_f32 v42, v104, v43
    v_sub_f32 v43, v73, v40
    v_mul_f32 v43, 0x3e0293ee, v43
    v_exp_f32 v43, v43
    s_nop 0
    v_fmac_f32 v41, v89, v43
    v_fmac_f32 v42, v105, v43
    v_sub_f32 v43, v74, v40
    v_mul_f32 v43, 0x3e0293ee, v43
    v_exp_f32 v43, v43
    s_nop 0
    v_fmac_f32 v41, v90, v43
    v_fmac_f32 v42, v106, v43
    v_sub_f32 v43, v75, v40
    v_mul_f32 v43, 0x3e0293ee, v43
    v_exp_f32 v43, v43
    s_nop 0
    v_fmac_f32 v41, v91, v43
    v_fmac_f32 v42, v107, v43
    v_sub_f32 v43, v76, v40
    v_mul_f32 v43, 0x3e0293ee, v43
    v_exp_f32 v43, v43
    s_nop 0
    v_fmac_f32 v41, v92, v43
    v_fmac_f32 v42, v108, v43
    v_sub_f32 v43, v77, v40
    v_mul_f32 v43, 0x3e0293ee, v43
    v_exp_f32 v43, v43
    s_nop 0
    v_fmac_f32 v41, v93, v43
    v_fmac_f32 v42, v109, v43
    v_sub_f32 v43, v78, v40
    v_mul_f32 v43, 0x3e0293ee, v43
    v_exp_f32 v43, v43
    s_nop 0
    v_fmac_f32 v41, v94, v43
    v_fmac_f32 v42, v110, v43
    v_sub_f32 v43, v79, v40
    v_mul_f32 v43, 0x3e0293ee, v43
    v_exp_f32 v43, v43
    s_nop 0
    v_fmac_f32 v41, v95, v43
    v_fmac_f32 v42, v111, v43
    v_rcp_f32 v41, v41
    s_nop 0
    v_mul_f32 v42, v42, v41
    v_cvt_pk_bf16_f32 v42, v42, v42
    v_and_b32 v42, 0xffff0000, v42
    v_lshlrev_b32 v45, 2, v0
    ds_write_b32 v45, v42 offset:16384
    s_waitcnt lgkmcnt(0)
    s_barrier
    v_lshlrev_b32 v45, 4, v1
    ds_read_b128 v[24:27], v45 offset:16384
    ds_read_b128 v[28:31], v45 offset:16896
    s_waitcnt lgkmcnt(0)
    v_mov_b32 v44, 0
    v_mov_b32 v45, 0
    v_mov_b32 v46, 0
    v_mov_b32 v47, 0
    v_mov_b32 v48, 0
    v_mov_b32 v49, 0
    v_mov_b32 v50, 0
    v_mov_b32 v51, 0
    v_mov_b32 v52, 0
    v_mov_b32 v53, 0
    v_mov_b32 v54, 0
    v_mov_b32 v55, 0
    v_mov_b32 v56, 0
    v_mov_b32 v57, 0
    v_mov_b32 v58, 0
    v_mov_b32 v59, 0
    v_lshlrev_b32 v41, 16, v8
    v_and_b32 v42, 0xffff0000, v8
    v_fmac_f32 v44, v24, v41
    v_fmac_f32 v45, v24, v42
    v_fmac_f32 v52, v28, v41
    v_fmac_f32 v53, v28, v42
    v_lshlrev_b32 v41, 16, v9
    v_and_b32 v42, 0xffff0000, v9
    v_fmac_f32 v46, v24, v41
    v_fmac_f32 v47, v24, v42
    v_fmac_f32 v54, v28, v41
    v_fmac_f32 v55, v28, v42
    v_lshlrev_b32 v41, 16, v10
    v_and_b32 v42, 0xffff0000, v10
    v_fmac_f32 v48, v24, v41
    v_fmac_f32 v49, v24, v42
    v_fmac_f32 v56, v28, v41
    v_fmac_f32 v57, v28, v42
    v_lshlrev_b32 v41, 16, v11
    v_and_b32 v42, 0xffff0000, v11
    v_fmac_f32 v50, v24, v41
    v_fmac_f32 v51, v24, v42
    v_fmac_f32 v58, v28, v41
    v_fmac_f32 v59, v28, v42
    v_lshlrev_b32 v41, 16, v12
    v_and_b32 v42, 0xffff0000, v12
    v_fmac_f32 v44, v25, v41
    v_fmac_f32 v45, v25, v42
    v_fmac_f32 v52, v29, v41
    v_fmac_f32 v53, v29, v42
    v_lshlrev_b32 v41, 16, v13
    v_and_b32 v42, 0xffff0000, v13
    v_fmac_f32 v46, v25, v41
    v_fmac_f32 v47, v25, v42
    v_fmac_f32 v54, v29, v41
    v_fmac_f32 v55, v29, v42
    v_lshlrev_b32 v41, 16, v14
    v_and_b32 v42, 0xffff0000, v14
    v_fmac_f32 v48, v25, v41
    v_fmac_f32 v49, v25, v42
    v_fmac_f32 v56, v29, v41
    v_fmac_f32 v57, v29, v42
    v_lshlrev_b32 v41, 16, v15
    v_and_b32 v42, 0xffff0000, v15
    v_fmac_f32 v50, v25, v41
    v_fmac_f32 v51, v25, v42
    v_fmac_f32 v58, v29, v41
    v_fmac_f32 v59, v29, v42
    v_lshlrev_b32 v41, 16, v16
    v_and_b32 v42, 0xffff0000, v16
    v_fmac_f32 v44, v26, v41
    v_fmac_f32 v45, v26, v42
    v_fmac_f32 v52, v30, v41
    v_fmac_f32 v53, v30, v42
    v_lshlrev_b32 v41, 16, v17
    v_and_b32 v42, 0xffff0000, v17
    v_fmac_f32 v46, v26, v41
    v_fmac_f32 v47, v26, v42
    v_fmac_f32 v54, v30, v41
    v_fmac_f32 v55, v30, v42
    v_lshlrev_b32 v41, 16, v18
    v_and_b32 v42, 0xffff0000, v18
    v_fmac_f32 v48, v26, v41
    v_fmac_f32 v49, v26, v42
    v_fmac_f32 v56, v30, v41
    v_fmac_f32 v57, v30, v42
    v_lshlrev_b32 v41, 16, v19
    v_and_b32 v42, 0xffff0000, v19
    v_fmac_f32 v50, v26, v41
    v_fmac_f32 v51, v26, v42
    v_fmac_f32 v58, v30, v41
    v_fmac_f32 v59, v30, v42
    v_lshlrev_b32 v41, 16, v20
    v_and_b32 v42, 0xffff0000, v20
    v_fmac_f32 v44, v27, v41
    v_fmac_f32 v45, v27, v42
    v_fmac_f32 v52, v31, v41
    v_fmac_f32 v53, v31, v42
    v_lshlrev_b32 v41, 16, v21
    v_and_b32 v42, 0xffff0000, v21
    v_fmac_f32 v46, v27, v41
    v_fmac_f32 v47, v27, v42
    v_fmac_f32 v54, v31, v41
    v_fmac_f32 v55, v31, v42
    v_lshlrev_b32 v41, 16, v22
    v_and_b32 v42, 0xffff0000, v22
    v_fmac_f32 v48, v27, v41
    v_fmac_f32 v49, v27, v42
    v_fmac_f32 v56, v31, v41
    v_fmac_f32 v57, v31, v42
    v_lshlrev_b32 v41, 16, v23
    v_and_b32 v42, 0xffff0000, v23
    v_fmac_f32 v50, v27, v41
    v_fmac_f32 v51, v27, v42
    v_fmac_f32 v58, v31, v41
    v_fmac_f32 v59, v31, v42
    v_lshlrev_b32 v60, 6, v0
    v_add_u32 v60, 0, v60
    ds_write_b128 v60, v[44:47] offset:0
    ds_write_b128 v60, v[48:51] offset:16
    ds_write_b128 v60, v[52:55] offset:32
    ds_write_b128 v60, v[56:59] offset:48
    s_waitcnt lgkmcnt(0)
    s_barrier
    v_lshlrev_b32 v60, 2, v0
    v_add_u32 v60, 0, v60
    ds_read_b32 v64, v60 offset:0
    ds_read_b32 v65, v60 offset:512
    ds_read_b32 v66, v60 offset:1024
    ds_read_b32 v67, v60 offset:1536
    ds_read_b32 v68, v60 offset:2048
    ds_read_b32 v69, v60 offset:2560
    ds_read_b32 v70, v60 offset:3072
    ds_read_b32 v71, v60 offset:3584
    ds_read_b32 v72, v60 offset:4096
    ds_read_b32 v73, v60 offset:4608
    ds_read_b32 v74, v60 offset:5120
    ds_read_b32 v75, v60 offset:5632
    ds_read_b32 v76, v60 offset:6144
    ds_read_b32 v77, v60 offset:6656
    ds_read_b32 v78, v60 offset:7168
    ds_read_b32 v79, v60 offset:7680
    ds_read_b32 v80, v60 offset:8192
    ds_read_b32 v81, v60 offset:8704
    ds_read_b32 v82, v60 offset:9216
    ds_read_b32 v83, v60 offset:9728
    ds_read_b32 v84, v60 offset:10240
    ds_read_b32 v85, v60 offset:10752
    ds_read_b32 v86, v60 offset:11264
    ds_read_b32 v87, v60 offset:11776
    ds_read_b32 v88, v60 offset:12288
    ds_read_b32 v89, v60 offset:12800
    ds_read_b32 v90, v60 offset:13312
    ds_read_b32 v91, v60 offset:13824
    ds_read_b32 v92, v60 offset:14336
    ds_read_b32 v93, v60 offset:14848
    ds_read_b32 v94, v60 offset:15360
    ds_read_b32 v95, v60 offset:15872
    s_waitcnt lgkmcnt(0)
    v_add_f32 v40, v64, v65
    v_add_f32 v40, v40, v66
    v_add_f32 v40, v40, v67
    v_add_f32 v40, v40, v68
    v_add_f32 v40, v40, v69
    v_add_f32 v40, v40, v70
    v_add_f32 v40, v40, v71
    v_add_f32 v40, v40, v72
    v_add_f32 v40, v40, v73
    v_add_f32 v40, v40, v74
    v_add_f32 v40, v40, v75
    v_add_f32 v40, v40, v76
    v_add_f32 v40, v40, v77
    v_add_f32 v40, v40, v78
    v_add_f32 v40, v40, v79
    v_add_f32 v40, v40, v80
    v_add_f32 v40, v40, v81
    v_add_f32 v40, v40, v82
    v_add_f32 v40, v40, v83
    v_add_f32 v40, v40, v84
    v_add_f32 v40, v40, v85
    v_add_f32 v40, v40, v86
    v_add_f32 v40, v40, v87
    v_add_f32 v40, v40, v88
    v_add_f32 v40, v40, v89
    v_add_f32 v40, v40, v90
    v_add_f32 v40, v40, v91
    v_add_f32 v40, v40, v92
    v_add_f32 v40, v40, v93
    v_add_f32 v40, v40, v94
    v_add_f32 v40, v40, v95
    v_cmp_gt_u32 vcc, 128, v0
    v_lshrrev_b32 v1, 4, v0
    v_bfe_u32 v2, v0, 3, 1
    v_and_b32 v3, 7, v0
    s_lshl_b32 s15, s11, 6
    v_lshl_add_u32 v4, v1, 3, v3
    v_lshlrev_b32 v5, 9, v2
    v_add3_u32 v4, v4, v5, s15
    v_lshlrev_b32 v4, 2, v4
    v_add_u32 v4, 802816, v4
    s_and_saveexec_b64 s[16:17], vcc
    s_cbranch_execz K4_END
    global_atomic_add_f32 v4, v40, s[8:9]
K4_END:
    s_endpgm
.section .rodata,"a"
.p2align 6
.amdhsa_kernel k4_kernel
  .amdhsa_next_free_vgpr 128
  .amdhsa_next_free_sgpr 102
  .amdhsa_accum_offset 128
  .amdhsa_group_segment_fixed_size 0
  .amdhsa_kernarg_size 112
  .amdhsa_user_sgpr_count 2
  .amdhsa_user_sgpr_kernarg_segment_ptr 1
  .amdhsa_system_sgpr_workgroup_id_x 1
.end_amdhsa_kernel
.text
.globl k5_kernel
.p2align 8
.type k5_kernel,@function
k5_kernel:
    s_cmp_ge_u32 s2, 224
    s_cbranch_scc1 K5_END
    s_load_dwordx2 s[4:5], s[0:1], 0
    s_load_dwordx2 s[6:7], s[0:1], 48
    s_load_dwordx2 s[18:19], s[0:1], 56
    s_load_dwordx2 s[8:9], s[0:1], 104
    s_and_b32 s10, s2, 7
    s_lshr_b32 s11, s2, 3
    v_lshrrev_b32 v1, 3, v0
    v_and_b32 v2, 7, v0
    s_lshl_b32 s12, s10, 6
    v_lshl_add_u32 v3, v1, 1, s12
    v_mul_u32_u24 v4, 0xe00, v3
    s_lshl_b32 s13, s11, 7
    v_lshl_add_u32 v5, v2, 4, s13
    v_add_u32 v4, v4, v5
    s_waitcnt lgkmcnt(0)
    global_load_dwordx4 v[8:11], v4, s[6:7]
    global_load_dwordx4 v[12:15], v4, s[6:7] offset:3584
    global_load_dwordx4 v[16:19], v4, s[18:19]
    global_load_dwordx4 v[20:23], v4, s[18:19] offset:3584
    v_and_b32 v6, 63, v0
    v_lshlrev_b32 v7, 4, v6
    global_load_dwordx4 v[24:27], v7, s[4:5]
    global_load_dwordx4 v[28:31], v7, s[4:5] offset:1024
    v_lshlrev_b32 v7, 5, v6
    v_add_u32 v7, 802816, v7
    global_load_dwordx4 v[64:67], v7, s[8:9]
    global_load_dwordx4 v[68:71], v7, s[8:9] offset:16
    global_load_dwordx4 v[72:75], v7, s[8:9] offset:2048
    global_load_dwordx4 v[76:79], v7, s[8:9] offset:2064
    v_lshlrev_b32 v7, 5, v6
    v_add_u32 v48, 888832, v7
    global_load_dwordx4 v[80:83], v48, s[8:9]
    global_load_dwordx4 v[84:87], v48, s[8:9] offset:16
    v_add_u32 v48, 901120, v7
    global_load_dwordx4 v[88:91], v48, s[8:9]
    global_load_dwordx4 v[92:95], v48, s[8:9] offset:16
    v_add_u32 v48, 890880, v7
    global_load_dwordx4 v[96:99], v48, s[8:9]
    global_load_dwordx4 v[100:103], v48, s[8:9] offset:16
    v_add_u32 v48, 903168, v7
    global_load_dwordx4 v[104:107], v48, s[8:9]
    global_load_dwordx4 v[108:111], v48, s[8:9] offset:16
    v_add_u32 v48, 892928, v7
    global_load_dwordx4 v[112:115], v48, s[8:9]
    global_load_dwordx4 v[116:119], v48, s[8:9] offset:16
    v_add_u32 v48, 905216, v7
    global_load_dwordx4 v[120:123], v48, s[8:9]
    global_load_dwordx4 v[124:127], v48, s[8:9] offset:16
    s_waitcnt vmcnt(0)
    v_lshlrev_b32 v128, 16, v24
    v_and_b32 v129, 0xffff0000, v24
    v_lshlrev_b32 v130, 16, v25
    v_and_b32 v131, 0xffff0000, v25
    v_lshlrev_b32 v132, 16, v26
    v_and_b32 v133, 0xffff0000, v26
    v_lshlrev_b32 v134, 16, v27
    v_and_b32 v135, 0xffff0000, v27
    v_lshlrev_b32 v136, 16, v28
    v_and_b32 v137, 0xffff0000, v28
    v_lshlrev_b32 v138, 16, v29
    v_and_b32 v139, 0xffff0000, v29
    v_lshlrev_b32 v140, 16, v30
    v_and_b32 v141, 0xffff0000, v30
    v_lshlrev_b32 v142, 16, v31
    v_and_b32 v143, 0xffff0000, v31
    v_cvt_pk_bf16_f32 v64, v64, v64
    v_and_b32 v64, 0xffff0000, v64
    v_mul_f32 v64, v80, v64
    v_cvt_pk_bf16_f32 v64, v64, v64
    v_and_b32 v64, 0xffff0000, v64
    v_add_f32 v128, v128, v64
    v_cvt_pk_bf16_f32 v128, v128, v128
    v_and_b32 v128, 0xffff0000, v128
    v_cvt_pk_bf16_f32 v65, v65, v65
    v_and_b32 v65, 0xffff0000, v65
    v_mul_f32 v65, v81, v65
    v_cvt_pk_bf16_f32 v65, v65, v65
    v_and_b32 v65, 0xffff0000, v65
    v_add_f32 v129, v129, v65
    v_cvt_pk_bf16_f32 v129, v129, v129
    v_and_b32 v129, 0xffff0000, v129
    v_cvt_pk_bf16_f32 v66, v66, v66
    v_and_b32 v66, 0xffff0000, v66
    v_mul_f32 v66, v82, v66
    v_cvt_pk_bf16_f32 v66, v66, v66
    v_and_b32 v66, 0xffff0000, v66
    v_add_f32 v130, v130, v66
    v_cvt_pk_bf16_f32 v130, v130, v130
    v_and_b32 v130, 0xffff0000, v130
    v_cvt_pk_bf16_f32 v67, v67, v67
    v_and_b32 v67, 0xffff0000, v67
    v_mul_f32 v67, v83, v67
    v_cvt_pk_bf16_f32 v67, v67, v67
    v_and_b32 v67, 0xffff0000, v67
    v_add_f32 v131, v131, v67
    v_cvt_pk_bf16_f32 v131, v131, v131
    v_and_b32 v131, 0xffff0000, v131
    v_cvt_pk_bf16_f32 v68, v68, v68
    v_and_b32 v68, 0xffff0000, v68
    v_mul_f32 v68, v84, v68
    v_cvt_pk_bf16_f32 v68, v68, v68
    v_and_b32 v68, 0xffff0000, v68
    v_add_f32 v132, v132, v68
    v_cvt_pk_bf16_f32 v132, v132, v132
    v_and_b32 v132, 0xffff0000, v132
    v_cvt_pk_bf16_f32 v69, v69, v69
    v_and_b32 v69, 0xffff0000, v69
    v_mul_f32 v69, v85, v69
    v_cvt_pk_bf16_f32 v69, v69, v69
    v_and_b32 v69, 0xffff0000, v69
    v_add_f32 v133, v133, v69
    v_cvt_pk_bf16_f32 v133, v133, v133
    v_and_b32 v133, 0xffff0000, v133
    v_cvt_pk_bf16_f32 v70, v70, v70
    v_and_b32 v70, 0xffff0000, v70
    v_mul_f32 v70, v86, v70
    v_cvt_pk_bf16_f32 v70, v70, v70
    v_and_b32 v70, 0xffff0000, v70
    v_add_f32 v134, v134, v70
    v_cvt_pk_bf16_f32 v134, v134, v134
    v_and_b32 v134, 0xffff0000, v134
    v_cvt_pk_bf16_f32 v71, v71, v71
    v_and_b32 v71, 0xffff0000, v71
    v_mul_f32 v71, v87, v71
    v_cvt_pk_bf16_f32 v71, v71, v71
    v_and_b32 v71, 0xffff0000, v71
    v_add_f32 v135, v135, v71
    v_cvt_pk_bf16_f32 v135, v135, v135
    v_and_b32 v135, 0xffff0000, v135
    v_cvt_pk_bf16_f32 v72, v72, v72
    v_and_b32 v72, 0xffff0000, v72
    v_mul_f32 v72, v88, v72
    v_cvt_pk_bf16_f32 v72, v72, v72
    v_and_b32 v72, 0xffff0000, v72
    v_add_f32 v136, v136, v72
    v_cvt_pk_bf16_f32 v136, v136, v136
    v_and_b32 v136, 0xffff0000, v136
    v_cvt_pk_bf16_f32 v73, v73, v73
    v_and_b32 v73, 0xffff0000, v73
    v_mul_f32 v73, v89, v73
    v_cvt_pk_bf16_f32 v73, v73, v73
    v_and_b32 v73, 0xffff0000, v73
    v_add_f32 v137, v137, v73
    v_cvt_pk_bf16_f32 v137, v137, v137
    v_and_b32 v137, 0xffff0000, v137
    v_cvt_pk_bf16_f32 v74, v74, v74
    v_and_b32 v74, 0xffff0000, v74
    v_mul_f32 v74, v90, v74
    v_cvt_pk_bf16_f32 v74, v74, v74
    v_and_b32 v74, 0xffff0000, v74
    v_add_f32 v138, v138, v74
    v_cvt_pk_bf16_f32 v138, v138, v138
    v_and_b32 v138, 0xffff0000, v138
    v_cvt_pk_bf16_f32 v75, v75, v75
    v_and_b32 v75, 0xffff0000, v75
    v_mul_f32 v75, v91, v75
    v_cvt_pk_bf16_f32 v75, v75, v75
    v_and_b32 v75, 0xffff0000, v75
    v_add_f32 v139, v139, v75
    v_cvt_pk_bf16_f32 v139, v139, v139
    v_and_b32 v139, 0xffff0000, v139
    v_cvt_pk_bf16_f32 v76, v76, v76
    v_and_b32 v76, 0xffff0000, v76
    v_mul_f32 v76, v92, v76
    v_cvt_pk_bf16_f32 v76, v76, v76
    v_and_b32 v76, 0xffff0000, v76
    v_add_f32 v140, v140, v76
    v_cvt_pk_bf16_f32 v140, v140, v140
    v_and_b32 v140, 0xffff0000, v140
    v_cvt_pk_bf16_f32 v77, v77, v77
    v_and_b32 v77, 0xffff0000, v77
    v_mul_f32 v77, v93, v77
    v_cvt_pk_bf16_f32 v77, v77, v77
    v_and_b32 v77, 0xffff0000, v77
    v_add_f32 v141, v141, v77
    v_cvt_pk_bf16_f32 v141, v141, v141
    v_and_b32 v141, 0xffff0000, v141
    v_cvt_pk_bf16_f32 v78, v78, v78
    v_and_b32 v78, 0xffff0000, v78
    v_mul_f32 v78, v94, v78
    v_cvt_pk_bf16_f32 v78, v78, v78
    v_and_b32 v78, 0xffff0000, v78
    v_add_f32 v142, v142, v78
    v_cvt_pk_bf16_f32 v142, v142, v142
    v_and_b32 v142, 0xffff0000, v142
    v_cvt_pk_bf16_f32 v79, v79, v79
    v_and_b32 v79, 0xffff0000, v79
    v_mul_f32 v79, v95, v79
    v_cvt_pk_bf16_f32 v79, v79, v79
    v_and_b32 v79, 0xffff0000, v79
    v_add_f32 v143, v143, v79
    v_cvt_pk_bf16_f32 v143, v143, v143
    v_and_b32 v143, 0xffff0000, v143
    v_lshlrev_b32 v7, 5, v6
    v_add_u32 v7, 868352, v7
    v_cmp_gt_u32 vcc, 64, v0
    s_cmp_eq_u32 s2, 0
    s_cselect_b64 s[16:17], vcc, 0
    s_and_saveexec_b64 s[16:17], s[16:17]
    s_cbranch_execz K5_NOX1
    global_store_dwordx4 v7, v[128:131], s[8:9]
    global_store_dwordx4 v7, v[132:135], s[8:9] offset:16
    global_store_dwordx4 v7, v[136:139], s[8:9] offset:2048
    global_store_dwordx4 v7, v[140:143], s[8:9] offset:2064
K5_NOX1:
    s_mov_b64 exec, s[16:17]
    v_add_f32 v64, v128, v129
    v_add_f32 v64, v64, v130
    v_add_f32 v64, v64, v131
    v_add_f32 v64, v64, v132
    v_add_f32 v64, v64, v133
    v_add_f32 v64, v64, v134
    v_add_f32 v64, v64, v135
    s_nop 1
    v_add_f32_dpp v64, v64, v64 quad_perm:[1,0,3,2] row_mask:0xf bank_mask:0xf
    s_nop 1
    v_add_f32_dpp v64, v64, v64 quad_perm:[2,3,0,1] row_mask:0xf bank_mask:0xf
    s_nop 1
    v_add_f32_dpp v64, v64, v64 row_half_mirror row_mask:0xf bank_mask:0xf
    s_nop 1
    v_add_f32_dpp v64, v64, v64 row_mirror row_mask:0xf bank_mask:0xf
    v_mov_b32 v65, v64
    s_nop 1
    v_permlane16_swap_b32 v65, v64
    s_nop 1
    v_add_f32 v64, v64, v65
    v_mov_b32 v65, v64
    s_nop 1
    v_permlane32_swap_b32 v65, v64
    s_nop 1
    v_add_f32 v64, v64, v65
    v_mul_f32 v64, 0x3b000000, v64
    v_sub_f32 v65, v128, v64
    v_mul_f32 v67, v65, v65
    v_sub_f32 v65, v129, v64
    v_fmac_f32 v67, v65, v65
    v_sub_f32 v65, v130, v64
    v_fmac_f32 v67, v65, v65
    v_sub_f32 v65, v131, v64
    v_fmac_f32 v67, v65, v65
    v_sub_f32 v65, v132, v64
    v_fmac_f32 v67, v65, v65
    v_sub_f32 v65, v133, v64
    v_fmac_f32 v67, v65, v65
    v_sub_f32 v65, v134, v64
    v_fmac_f32 v67, v65, v65
    v_sub_f32 v65, v135, v64
    v_fmac_f32 v67, v65, v65
    s_nop 1
    v_add_f32_dpp v67, v67, v67 quad_perm:[1,0,3,2] row_mask:0xf bank_mask:0xf
    s_nop 1
    v_add_f32_dpp v67, v67, v67 quad_perm:[2,3,0,1] row_mask:0xf bank_mask:0xf
    s_nop 1
    v_add_f32_dpp v67, v67, v67 row_half_mirror row_mask:0xf bank_mask:0xf
    s_nop 1
    v_add_f32_dpp v67, v67, v67 row_mirror row_mask:0xf bank_mask:0xf
    v_mov_b32 v65, v67
    s_nop 1
    v_permlane16_swap_b32 v65, v67
    s_nop 1
    v_add_f32 v67, v67, v65
    v_mov_b32 v65, v67
    s_nop 1
    v_permlane32_swap_b32 v65, v67
    s_nop 1
    v_add_f32 v67, v67, v65
    v_mul_f32 v67, 0x3b000000, v67
    v_cvt_pk_bf16_f32 v67, v67, v67
    v_and_b32 v67, 0xffff0000, v67
    v_add_f32 v67, 0x3727c5ac, v67
    v_cvt_pk_bf16_f32 v67, v67, v67
    v_and_b32 v67, 0xffff0000, v67
    v_sqrt_f32 v67, v67
    s_nop 0
    v_cvt_pk_bf16_f32 v67, v67, v67
    v_and_b32 v67, 0xffff0000, v67
    v_cvt_pk_bf16_f32 v66, v64, v64
    v_and_b32 v66, 0xffff0000, v66
    v_add_f32 v64, v136, v137
    v_add_f32 v64, v64, v138
    v_add_f32 v64, v64, v139
    v_add_f32 v64, v64, v140
    v_add_f32 v64, v64, v141
    v_add_f32 v64, v64, v142
    v_add_f32 v64, v64, v143
    s_nop 1
    v_add_f32_dpp v64, v64, v64 quad_perm:[1,0,3,2] row_mask:0xf bank_mask:0xf
    s_nop 1
    v_add_f32_dpp v64, v64, v64 quad_perm:[2,3,0,1] row_mask:0xf bank_mask:0xf
    s_nop 1
    v_add_f32_dpp v64, v64, v64 row_half_mirror row_mask:0xf bank_mask:0xf
    s_nop 1
    v_add_f32_dpp v64, v64, v64 row_mirror row_mask:0xf bank_mask:0xf
    v_mov_b32 v65, v64
    s_nop 1
    v_permlane16_swap_b32 v65, v64
    s_nop 1
    v_add_f32 v64, v64, v65
    v_mov_b32 v65, v64
    s_nop 1
    v_permlane32_swap_b32 v65, v64
    s_nop 1
    v_add_f32 v64, v64, v65
    v_mul_f32 v64, 0x3b000000, v64
    v_sub_f32 v65, v136, v64
    v_mul_f32 v69, v65, v65
    v_sub_f32 v65, v137, v64
    v_fmac_f32 v69, v65, v65
    v_sub_f32 v65, v138, v64
    v_fmac_f32 v69, v65, v65
    v_sub_f32 v65, v139, v64
    v_fmac_f32 v69, v65, v65
    v_sub_f32 v65, v140, v64
    v_fmac_f32 v69, v65, v65
    v_sub_f32 v65, v141, v64
    v_fmac_f32 v69, v65, v65
    v_sub_f32 v65, v142, v64
    v_fmac_f32 v69, v65, v65
    v_sub_f32 v65, v143, v64
    v_fmac_f32 v69, v65, v65
    s_nop 1
    v_add_f32_dpp v69, v69, v69 quad_perm:[1,0,3,2] row_mask:0xf bank_mask:0xf
    s_nop 1
    v_add_f32_dpp v69, v69, v69 quad_perm:[2,3,0,1] row_mask:0xf bank_mask:0xf
    s_nop 1
    v_add_f32_dpp v69, v69, v69 row_half_mirror row_mask:0xf bank_mask:0xf
    s_nop 1
    v_add_f32_dpp v69, v69, v69 row_mirror row_mask:0xf bank_mask:0xf
    v_mov_b32 v65, v69
    s_nop 1
    v_permlane16_swap_b32 v65, v69
    s_nop 1
    v_add_f32 v69, v69, v65
    v_mov_b32 v65, v69
    s_nop 1
    v_permlane32_swap_b32 v65, v69
    s_nop 1
    v_add_f32 v69, v69, v65
    v_mul_f32 v69, 0x3b000000, v69
    v_cvt_pk_bf16_f32 v69, v69, v69
    v_and_b32 v69, 0xffff0000, v69
    v_add_f32 v69, 0x3727c5ac, v69
    v_cvt_pk_bf16_f32 v69, v69, v69
    v_and_b32 v69, 0xffff0000, v69
    v_sqrt_f32 v69, v69
    s_nop 0
    v_cvt_pk_bf16_f32 v69, v69, v69
    v_and_b32 v69, 0xffff0000, v69
    v_cvt_pk_bf16_f32 v68, v64, v64
    v_and_b32 v68, 0xffff0000, v68
    v_rcp_f32 v67, v67
    v_rcp_f32 v69, v69
    s_nop 0
    v_sub_f32 v128, v128, v66
    v_cvt_pk_bf16_f32 v128, v128, v128
    v_and_b32 v128, 0xffff0000, v128
    v_mul_f32 v128, v128, v67
    v_cvt_pk_bf16_f32 v128, v128, v128
    v_and_b32 v128, 0xffff0000, v128
    v_add_f32 v112, 1.0, v112
    v_cvt_pk_bf16_f32 v112, v112, v112
    v_and_b32 v112, 0xffff0000, v112
    v_mul_f32 v128, v128, v112
    v_cvt_pk_bf16_f32 v128, v128, v128
    v_and_b32 v128, 0xffff0000, v128
    v_add_f32 v128, v128, v96
    v_cvt_pk_bf16_f32 v128, v128, v128
    v_and_b32 v128, 0xffff0000, v128
    v_sub_f32 v129, v129, v66
    v_cvt_pk_bf16_f32 v129, v129, v129
    v_and_b32 v129, 0xffff0000, v129
    v_mul_f32 v129, v129, v67
    v_cvt_pk_bf16_f32 v129, v129, v129
    v_and_b32 v129, 0xffff0000, v129
    v_add_f32 v113, 1.0, v113
    v_cvt_pk_bf16_f32 v113, v113, v113
    v_and_b32 v113, 0xffff0000, v113
    v_mul_f32 v129, v129, v113
    v_cvt_pk_bf16_f32 v129, v129, v129
    v_and_b32 v129, 0xffff0000, v129
    v_add_f32 v129, v129, v97
    v_cvt_pk_bf16_f32 v129, v129, v129
    v_and_b32 v129, 0xffff0000, v129
    v_sub_f32 v130, v130, v66
    v_cvt_pk_bf16_f32 v130, v130, v130
    v_and_b32 v130, 0xffff0000, v130
    v_mul_f32 v130, v130, v67
    v_cvt_pk_bf16_f32 v130, v130, v130
    v_and_b32 v130, 0xffff0000, v130
    v_add_f32 v114, 1.0, v114
    v_cvt_pk_bf16_f32 v114, v114, v114
    v_and_b32 v114, 0xffff0000, v114
    v_mul_f32 v130, v130, v114
    v_cvt_pk_bf16_f32 v130, v130, v130
    v_and_b32 v130, 0xffff0000, v130
    v_add_f32 v130, v130, v98
    v_cvt_pk_bf16_f32 v130, v130, v130
    v_and_b32 v130, 0xffff0000, v130
    v_sub_f32 v131, v131, v66
    v_cvt_pk_bf16_f32 v131, v131, v131
    v_and_b32 v131, 0xffff0000, v131
    v_mul_f32 v131, v131, v67
    v_cvt_pk_bf16_f32 v131, v131, v131
    v_and_b32 v131, 0xffff0000, v131
    v_add_f32 v115, 1.0, v115
    v_cvt_pk_bf16_f32 v115, v115, v115
    v_and_b32 v115, 0xffff0000, v115
    v_mul_f32 v131, v131, v115
    v_cvt_pk_bf16_f32 v131, v131, v131
    v_and_b32 v131, 0xffff0000, v131
    v_add_f32 v131, v131, v99
    v_cvt_pk_bf16_f32 v131, v131, v131
    v_and_b32 v131, 0xffff0000, v131
    v_sub_f32 v132, v132, v66
    v_cvt_pk_bf16_f32 v132, v132, v132
    v_and_b32 v132, 0xffff0000, v132
    v_mul_f32 v132, v132, v67
    v_cvt_pk_bf16_f32 v132, v132, v132
    v_and_b32 v132, 0xffff0000, v132
    v_add_f32 v116, 1.0, v116
    v_cvt_pk_bf16_f32 v116, v116, v116
    v_and_b32 v116, 0xffff0000, v116
    v_mul_f32 v132, v132, v116
    v_cvt_pk_bf16_f32 v132, v132, v132
    v_and_b32 v132, 0xffff0000, v132
    v_add_f32 v132, v132, v100
    v_cvt_pk_bf16_f32 v132, v132, v132
    v_and_b32 v132, 0xffff0000, v132
    v_sub_f32 v133, v133, v66
    v_cvt_pk_bf16_f32 v133, v133, v133
    v_and_b32 v133, 0xffff0000, v133
    v_mul_f32 v133, v133, v67
    v_cvt_pk_bf16_f32 v133, v133, v133
    v_and_b32 v133, 0xffff0000, v133
    v_add_f32 v117, 1.0, v117
    v_cvt_pk_bf16_f32 v117, v117, v117
    v_and_b32 v117, 0xffff0000, v117
    v_mul_f32 v133, v133, v117
    v_cvt_pk_bf16_f32 v133, v133, v133
    v_and_b32 v133, 0xffff0000, v133
    v_add_f32 v133, v133, v101
    v_cvt_pk_bf16_f32 v133, v133, v133
    v_and_b32 v133, 0xffff0000, v133
    v_sub_f32 v134, v134, v66
    v_cvt_pk_bf16_f32 v134, v134, v134
    v_and_b32 v134, 0xffff0000, v134
    v_mul_f32 v134, v134, v67
    v_cvt_pk_bf16_f32 v134, v134, v134
    v_and_b32 v134, 0xffff0000, v134
    v_add_f32 v118, 1.0, v118
    v_cvt_pk_bf16_f32 v118, v118, v118
    v_and_b32 v118, 0xffff0000, v118
    v_mul_f32 v134, v134, v118
    v_cvt_pk_bf16_f32 v134, v134, v134
    v_and_b32 v134, 0xffff0000, v134
    v_add_f32 v134, v134, v102
    v_cvt_pk_bf16_f32 v134, v134, v134
    v_and_b32 v134, 0xffff0000, v134
    v_sub_f32 v135, v135, v66
    v_cvt_pk_bf16_f32 v135, v135, v135
    v_and_b32 v135, 0xffff0000, v135
    v_mul_f32 v135, v135, v67
    v_cvt_pk_bf16_f32 v135, v135, v135
    v_and_b32 v135, 0xffff0000, v135
    v_add_f32 v119, 1.0, v119
    v_cvt_pk_bf16_f32 v119, v119, v119
    v_and_b32 v119, 0xffff0000, v119
    v_mul_f32 v135, v135, v119
    v_cvt_pk_bf16_f32 v135, v135, v135
    v_and_b32 v135, 0xffff0000, v135
    v_add_f32 v135, v135, v103
    v_cvt_pk_bf16_f32 v135, v135, v135
    v_and_b32 v135, 0xffff0000, v135
    v_sub_f32 v136, v136, v68
    v_cvt_pk_bf16_f32 v136, v136, v136
    v_and_b32 v136, 0xffff0000, v136
    v_mul_f32 v136, v136, v69
    v_cvt_pk_bf16_f32 v136, v136, v136
    v_and_b32 v136, 0xffff0000, v136
    v_add_f32 v120, 1.0, v120
    v_cvt_pk_bf16_f32 v120, v120, v120
    v_and_b32 v120, 0xffff0000, v120
    v_mul_f32 v136, v136, v120
    v_cvt_pk_bf16_f32 v136, v136, v136
    v_and_b32 v136, 0xffff0000, v136
    v_add_f32 v136, v136, v104
    v_cvt_pk_bf16_f32 v136, v136, v136
    v_and_b32 v136, 0xffff0000, v136
    v_sub_f32 v137, v137, v68
    v_cvt_pk_bf16_f32 v137, v137, v137
    v_and_b32 v137, 0xffff0000, v137
    v_mul_f32 v137, v137, v69
    v_cvt_pk_bf16_f32 v137, v137, v137
    v_and_b32 v137, 0xffff0000, v137
    v_add_f32 v121, 1.0, v121
    v_cvt_pk_bf16_f32 v121, v121, v121
    v_and_b32 v121, 0xffff0000, v121
    v_mul_f32 v137, v137, v121
    v_cvt_pk_bf16_f32 v137, v137, v137
    v_and_b32 v137, 0xffff0000, v137
    v_add_f32 v137, v137, v105
    v_cvt_pk_bf16_f32 v137, v137, v137
    v_and_b32 v137, 0xffff0000, v137
    v_sub_f32 v138, v138, v68
    v_cvt_pk_bf16_f32 v138, v138, v138
    v_and_b32 v138, 0xffff0000, v138
    v_mul_f32 v138, v138, v69
    v_cvt_pk_bf16_f32 v138, v138, v138
    v_and_b32 v138, 0xffff0000, v138
    v_add_f32 v122, 1.0, v122
    v_cvt_pk_bf16_f32 v122, v122, v122
    v_and_b32 v122, 0xffff0000, v122
    v_mul_f32 v138, v138, v122
    v_cvt_pk_bf16_f32 v138, v138, v138
    v_and_b32 v138, 0xffff0000, v138
    v_add_f32 v138, v138, v106
    v_cvt_pk_bf16_f32 v138, v138, v138
    v_and_b32 v138, 0xffff0000, v138
    v_sub_f32 v139, v139, v68
    v_cvt_pk_bf16_f32 v139, v139, v139
    v_and_b32 v139, 0xffff0000, v139
    v_mul_f32 v139, v139, v69
    v_cvt_pk_bf16_f32 v139, v139, v139
    v_and_b32 v139, 0xffff0000, v139
    v_add_f32 v123, 1.0, v123
    v_cvt_pk_bf16_f32 v123, v123, v123
    v_and_b32 v123, 0xffff0000, v123
    v_mul_f32 v139, v139, v123
    v_cvt_pk_bf16_f32 v139, v139, v139
    v_and_b32 v139, 0xffff0000, v139
    v_add_f32 v139, v139, v107
    v_cvt_pk_bf16_f32 v139, v139, v139
    v_and_b32 v139, 0xffff0000, v139
    v_sub_f32 v140, v140, v68
    v_cvt_pk_bf16_f32 v140, v140, v140
    v_and_b32 v140, 0xffff0000, v140
    v_mul_f32 v140, v140, v69
    v_cvt_pk_bf16_f32 v140, v140, v140
    v_and_b32 v140, 0xffff0000, v140
    v_add_f32 v124, 1.0, v124
    v_cvt_pk_bf16_f32 v124, v124, v124
    v_and_b32 v124, 0xffff0000, v124
    v_mul_f32 v140, v140, v124
    v_cvt_pk_bf16_f32 v140, v140, v140
    v_and_b32 v140, 0xffff0000, v140
    v_add_f32 v140, v140, v108
    v_cvt_pk_bf16_f32 v140, v140, v140
    v_and_b32 v140, 0xffff0000, v140
    v_sub_f32 v141, v141, v68
    v_cvt_pk_bf16_f32 v141, v141, v141
    v_and_b32 v141, 0xffff0000, v141
    v_mul_f32 v141, v141, v69
    v_cvt_pk_bf16_f32 v141, v141, v141
    v_and_b32 v141, 0xffff0000, v141
    v_add_f32 v125, 1.0, v125
    v_cvt_pk_bf16_f32 v125, v125, v125
    v_and_b32 v125, 0xffff0000, v125
    v_mul_f32 v141, v141, v125
    v_cvt_pk_bf16_f32 v141, v141, v141
    v_and_b32 v141, 0xffff0000, v141
    v_add_f32 v141, v141, v109
    v_cvt_pk_bf16_f32 v141, v141, v141
    v_and_b32 v141, 0xffff0000, v141
    v_sub_f32 v142, v142, v68
    v_cvt_pk_bf16_f32 v142, v142, v142
    v_and_b32 v142, 0xffff0000, v142
    v_mul_f32 v142, v142, v69
    v_cvt_pk_bf16_f32 v142, v142, v142
    v_and_b32 v142, 0xffff0000, v142
    v_add_f32 v126, 1.0, v126
    v_cvt_pk_bf16_f32 v126, v126, v126
    v_and_b32 v126, 0xffff0000, v126
    v_mul_f32 v142, v142, v126
    v_cvt_pk_bf16_f32 v142, v142, v142
    v_and_b32 v142, 0xffff0000, v142
    v_add_f32 v142, v142, v110
    v_cvt_pk_bf16_f32 v142, v142, v142
    v_and_b32 v142, 0xffff0000, v142
    v_sub_f32 v143, v143, v68
    v_cvt_pk_bf16_f32 v143, v143, v143
    v_and_b32 v143, 0xffff0000, v143
    v_mul_f32 v143, v143, v69
    v_cvt_pk_bf16_f32 v143, v143, v143
    v_and_b32 v143, 0xffff0000, v143
    v_add_f32 v127, 1.0, v127
    v_cvt_pk_bf16_f32 v127, v127, v127
    v_and_b32 v127, 0xffff0000, v127
    v_mul_f32 v143, v143, v127
    v_cvt_pk_bf16_f32 v143, v143, v143
    v_and_b32 v143, 0xffff0000, v143
    v_add_f32 v143, v143, v111
    v_cvt_pk_bf16_f32 v143, v143, v143
    v_and_b32 v143, 0xffff0000, v143
    v_lshlrev_b32 v7, 5, v6
    ds_write_b128 v7, v[128:131] offset:16384
    ds_write_b128 v7, v[132:135] offset:16400
    ds_write_b128 v7, v[136:139] offset:18432
    ds_write_b128 v7, v[140:143] offset:18448
    s_waitcnt lgkmcnt(0)
    s_barrier
    v_lshlrev_b32 v7, 2, v3
    ds_read_b64 v[24:25], v7 offset:16384
    ds_read_b64 v[26:27], v7 offset:18432
    s_waitcnt lgkmcnt(0)
    v_mov_b32 v44, 0
    v_mov_b32 v45, 0
    v_mov_b32 v46, 0
    v_mov_b32 v47, 0
    v_mov_b32 v48, 0
    v_mov_b32 v49, 0
    v_mov_b32 v50, 0
    v_mov_b32 v51, 0
    v_mov_b32 v52, 0
    v_mov_b32 v53, 0
    v_mov_b32 v54, 0
    v_mov_b32 v55, 0
    v_mov_b32 v56, 0
    v_mov_b32 v57, 0
    v_mov_b32 v58, 0
    v_mov_b32 v59, 0
    v_lshlrev_b32 v41, 16, v8
    v_and_b32 v42, 0xffff0000, v8
    v_fmac_f32 v44, v24, v41
    v_fmac_f32 v45, v24, v42
    v_fmac_f32 v52, v26, v41
    v_fmac_f32 v53, v26, v42
    v_lshlrev_b32 v41, 16, v9
    v_and_b32 v42, 0xffff0000, v9
    v_fmac_f32 v46, v24, v41
    v_fmac_f32 v47, v24, v42
    v_fmac_f32 v54, v26, v41
    v_fmac_f32 v55, v26, v42
    v_lshlrev_b32 v41, 16, v10
    v_and_b32 v42, 0xffff0000, v10
    v_fmac_f32 v48, v24, v41
    v_fmac_f32 v49, v24, v42
    v_fmac_f32 v56, v26, v41
    v_fmac_f32 v57, v26, v42
    v_lshlrev_b32 v41, 16, v11
    v_and_b32 v42, 0xffff0000, v11
    v_fmac_f32 v50, v24, v41
    v_fmac_f32 v51, v24, v42
    v_fmac_f32 v58, v26, v41
    v_fmac_f32 v59, v26, v42
    v_lshlrev_b32 v41, 16, v12
    v_and_b32 v42, 0xffff0000, v12
    v_fmac_f32 v44, v25, v41
    v_fmac_f32 v45, v25, v42
    v_fmac_f32 v52, v27, v41
    v_fmac_f32 v53, v27, v42
    v_lshlrev_b32 v41, 16, v13
    v_and_b32 v42, 0xffff0000, v13
    v_fmac_f32 v46, v25, v41
    v_fmac_f32 v47, v25, v42
    v_fmac_f32 v54, v27, v41
    v_fmac_f32 v55, v27, v42
    v_lshlrev_b32 v41, 16, v14
    v_and_b32 v42, 0xffff0000, v14
    v_fmac_f32 v48, v25, v41
    v_fmac_f32 v49, v25, v42
    v_fmac_f32 v56, v27, v41
    v_fmac_f32 v57, v27, v42
    v_lshlrev_b32 v41, 16, v15
    v_and_b32 v42, 0xffff0000, v15
    v_fmac_f32 v50, v25, v41
    v_fmac_f32 v51, v25, v42
    v_fmac_f32 v58, v27, v41
    v_fmac_f32 v59, v27, v42
    v_mov_b32 v144, 0
    v_mov_b32 v145, 0
    v_mov_b32 v146, 0
    v_mov_b32 v147, 0
    v_mov_b32 v148, 0
    v_mov_b32 v149, 0
    v_mov_b32 v150, 0
    v_mov_b32 v151, 0
    v_mov_b32 v152, 0
    v_mov_b32 v153, 0
    v_mov_b32 v154, 0
    v_mov_b32 v155, 0
    v_mov_b32 v156, 0
    v_mov_b32 v157, 0
    v_mov_b32 v158, 0
    v_mov_b32 v159, 0
    v_lshlrev_b32 v41, 16, v16
    v_and_b32 v42, 0xffff0000, v16
    v_fmac_f32 v144, v24, v41
    v_fmac_f32 v145, v24, v42
    v_fmac_f32 v152, v26, v41
    v_fmac_f32 v153, v26, v42
    v_lshlrev_b32 v41, 16, v17
    v_and_b32 v42, 0xffff0000, v17
    v_fmac_f32 v146, v24, v41
    v_fmac_f32 v147, v24, v42
    v_fmac_f32 v154, v26, v41
    v_fmac_f32 v155, v26, v42
    v_lshlrev_b32 v41, 16, v18
    v_and_b32 v42, 0xffff0000, v18
    v_fmac_f32 v148, v24, v41
    v_fmac_f32 v149, v24, v42
    v_fmac_f32 v156, v26, v41
    v_fmac_f32 v157, v26, v42
    v_lshlrev_b32 v41, 16, v19
    v_and_b32 v42, 0xffff0000, v19
    v_fmac_f32 v150, v24, v41
    v_fmac_f32 v151, v24, v42
    v_fmac_f32 v158, v26, v41
    v_fmac_f32 v159, v26, v42
    v_lshlrev_b32 v41, 16, v20
    v_and_b32 v42, 0xffff0000, v20
    v_fmac_f32 v144, v25, v41
    v_fmac_f32 v145, v25, v42
    v_fmac_f32 v152, v27, v41
    v_fmac_f32 v153, v27, v42
    v_lshlrev_b32 v41, 16, v21
    v_and_b32 v42, 0xffff0000, v21
    v_fmac_f32 v146, v25, v41
    v_fmac_f32 v147, v25, v42
    v_fmac_f32 v154, v27, v41
    v_fmac_f32 v155, v27, v42
    v_lshlrev_b32 v41, 16, v22
    v_and_b32 v42, 0xffff0000, v22
    v_fmac_f32 v148, v25, v41
    v_fmac_f32 v149, v25, v42
    v_fmac_f32 v156, v27, v41
    v_fmac_f32 v157, v27, v42
    v_lshlrev_b32 v41, 16, v23
    v_and_b32 v42, 0xffff0000, v23
    v_fmac_f32 v150, v25, v41
    v_fmac_f32 v151, v25, v42
    v_fmac_f32 v158, v27, v41
    v_fmac_f32 v159, v27, v42
    v_lshlrev_b32 v60, 6, v0
    v_add_u32 v60, 0, v60
    ds_write_b128 v60, v[44:47] offset:0
    ds_write_b128 v60, v[48:51] offset:16
    ds_write_b128 v60, v[52:55] offset:32
    ds_write_b128 v60, v[56:59] offset:48
    s_waitcnt lgkmcnt(0)
    s_barrier
    v_lshlrev_b32 v60, 2, v0
    v_add_u32 v60, 0, v60
    ds_read_b32 v64, v60 offset:0
    ds_read_b32 v65, v60 offset:512
    ds_read_b32 v66, v60 offset:1024
    ds_read_b32 v67, v60 offset:1536
    ds_read_b32 v68, v60 offset:2048
    ds_read_b32 v69, v60 offset:2560
    ds_read_b32 v70, v60 offset:3072
    ds_read_b32 v71, v60 offset:3584
    ds_read_b32 v72, v60 offset:4096
    ds_read_b32 v73, v60 offset:4608
    ds_read_b32 v74, v60 offset:5120
    ds_read_b32 v75, v60 offset:5632
    ds_read_b32 v76, v60 offset:6144
    ds_read_b32 v77, v60 offset:6656
    ds_read_b32 v78, v60 offset:7168
    ds_read_b32 v79, v60 offset:7680
    ds_read_b32 v80, v60 offset:8192
    ds_read_b32 v81, v60 offset:8704
    ds_read_b32 v82, v60 offset:9216
    ds_read_b32 v83, v60 offset:9728
    ds_read_b32 v84, v60 offset:10240
    ds_read_b32 v85, v60 offset:10752
    ds_read_b32 v86, v60 offset:11264
    ds_read_b32 v87, v60 offset:11776
    ds_read_b32 v88, v60 offset:12288
    ds_read_b32 v89, v60 offset:12800
    ds_read_b32 v90, v60 offset:13312
    ds_read_b32 v91, v60 offset:13824
    ds_read_b32 v92, v60 offset:14336
    ds_read_b32 v93, v60 offset:14848
    ds_read_b32 v94, v60 offset:15360
    ds_read_b32 v95, v60 offset:15872
    s_waitcnt lgkmcnt(0)
    v_add_f32 v40, v64, v65
    v_add_f32 v40, v40, v66
    v_add_f32 v40, v40, v67
    v_add_f32 v40, v40, v68
    v_add_f32 v40, v40, v69
    v_add_f32 v40, v40, v70
    v_add_f32 v40, v40, v71
    v_add_f32 v40, v40, v72
    v_add_f32 v40, v40, v73
    v_add_f32 v40, v40, v74
    v_add_f32 v40, v40, v75
    v_add_f32 v40, v40, v76
    v_add_f32 v40, v40, v77
    v_add_f32 v40, v40, v78
    v_add_f32 v40, v40, v79
    v_add_f32 v40, v40, v80
    v_add_f32 v40, v40, v81
    v_add_f32 v40, v40, v82
    v_add_f32 v40, v40, v83
    v_add_f32 v40, v40, v84
    v_add_f32 v40, v40, v85
    v_add_f32 v40, v40, v86
    v_add_f32 v40, v40, v87
    v_add_f32 v40, v40, v88
    v_add_f32 v40, v40, v89
    v_add_f32 v40, v40, v90
    v_add_f32 v40, v40, v91
    v_add_f32 v40, v40, v92
    v_add_f32 v40, v40, v93
    v_add_f32 v40, v40, v94
    v_add_f32 v40, v40, v95
    v_mov_b32 v160, v40
    s_barrier
    v_lshlrev_b32 v60, 6, v0
    v_add_u32 v60, 0, v60
    ds_write_b128 v60, v[144:147] offset:0
    ds_write_b128 v60, v[148:151] offset:16
    ds_write_b128 v60, v[152:155] offset:32
    ds_write_b128 v60, v[156:159] offset:48
    s_waitcnt lgkmcnt(0)
    s_barrier
    v_lshlrev_b32 v60, 2, v0
    v_add_u32 v60, 0, v60
    ds_read_b32 v64, v60 offset:0
    ds_read_b32 v65, v60 offset:512
    ds_read_b32 v66, v60 offset:1024
    ds_read_b32 v67, v60 offset:1536
    ds_read_b32 v68, v60 offset:2048
    ds_read_b32 v69, v60 offset:2560
    ds_read_b32 v70, v60 offset:3072
    ds_read_b32 v71, v60 offset:3584
    ds_read_b32 v72, v60 offset:4096
    ds_read_b32 v73, v60 offset:4608
    ds_read_b32 v74, v60 offset:5120
    ds_read_b32 v75, v60 offset:5632
    ds_read_b32 v76, v60 offset:6144
    ds_read_b32 v77, v60 offset:6656
    ds_read_b32 v78, v60 offset:7168
    ds_read_b32 v79, v60 offset:7680
    ds_read_b32 v80, v60 offset:8192
    ds_read_b32 v81, v60 offset:8704
    ds_read_b32 v82, v60 offset:9216
    ds_read_b32 v83, v60 offset:9728
    ds_read_b32 v84, v60 offset:10240
    ds_read_b32 v85, v60 offset:10752
    ds_read_b32 v86, v60 offset:11264
    ds_read_b32 v87, v60 offset:11776
    ds_read_b32 v88, v60 offset:12288
    ds_read_b32 v89, v60 offset:12800
    ds_read_b32 v90, v60 offset:13312
    ds_read_b32 v91, v60 offset:13824
    ds_read_b32 v92, v60 offset:14336
    ds_read_b32 v93, v60 offset:14848
    ds_read_b32 v94, v60 offset:15360
    ds_read_b32 v95, v60 offset:15872
    s_waitcnt lgkmcnt(0)
    v_add_f32 v40, v64, v65
    v_add_f32 v40, v40, v66
    v_add_f32 v40, v40, v67
    v_add_f32 v40, v40, v68
    v_add_f32 v40, v40, v69
    v_add_f32 v40, v40, v70
    v_add_f32 v40, v40, v71
    v_add_f32 v40, v40, v72
    v_add_f32 v40, v40, v73
    v_add_f32 v40, v40, v74
    v_add_f32 v40, v40, v75
    v_add_f32 v40, v40, v76
    v_add_f32 v40, v40, v77
    v_add_f32 v40, v40, v78
    v_add_f32 v40, v40, v79
    v_add_f32 v40, v40, v80
    v_add_f32 v40, v40, v81
    v_add_f32 v40, v40, v82
    v_add_f32 v40, v40, v83
    v_add_f32 v40, v40, v84
    v_add_f32 v40, v40, v85
    v_add_f32 v40, v40, v86
    v_add_f32 v40, v40, v87
    v_add_f32 v40, v40, v88
    v_add_f32 v40, v40, v89
    v_add_f32 v40, v40, v90
    v_add_f32 v40, v40, v91
    v_add_f32 v40, v40, v92
    v_add_f32 v40, v40, v93
    v_add_f32 v40, v40, v94
    v_add_f32 v40, v40, v95
    v_cmp_gt_u32 vcc, 128, v0
    v_lshrrev_b32 v1, 4, v0
    v_bfe_u32 v2, v0, 3, 1
    v_and_b32 v3, 7, v0
    s_lshl_b32 s15, s11, 6
    v_lshl_add_u32 v4, v1, 3, v3
    v_mul_u32_u24 v5, 1792, v2
    v_add3_u32 v4, v4, v5, s15
    v_lshlrev_b32 v4, 2, v4
    v_add_u32 v4, 819200, v4
    v_add_u32 v5, 14336, v4
    s_and_saveexec_b64 s[16:17], vcc
    s_cbranch_execz K5_END
    global_atomic_add_f32 v4, v160, s[8:9]
    global_atomic_add_f32 v5, v40, s[8:9]
K5_END:
    s_endpgm
.section .rodata,"a"
.p2align 6
.amdhsa_kernel k5_kernel
  .amdhsa_next_free_vgpr 168
  .amdhsa_next_free_sgpr 102
  .amdhsa_accum_offset 168
  .amdhsa_group_segment_fixed_size 0
  .amdhsa_kernarg_size 112
  .amdhsa_user_sgpr_count 2
  .amdhsa_user_sgpr_kernarg_segment_ptr 1
  .amdhsa_system_sgpr_workgroup_id_x 1
.end_amdhsa_kernel
.text
.globl k6_kernel
.p2align 8
.type k6_kernel,@function
k6_kernel:
    s_cmp_ge_u32 s2, 224
    s_cbranch_scc1 K6_END
    s_load_dwordx2 s[6:7], s[0:1], 64
    s_load_dwordx2 s[8:9], s[0:1], 104
    s_and_b32 s11, s2, 7
    s_lshr_b32 s10, s2, 3
    v_lshrrev_b32 v1, 3, v0
    v_and_b32 v2, 7, v0
    s_lshl_b32 s12, s10, 6
    v_lshl_add_u32 v3, v1, 1, s12
    v_lshlrev_b32 v4, 10, v3
    s_lshl_b32 s13, s11, 7
    v_lshl_add_u32 v5, v2, 4, s13
    v_add_u32 v4, v4, v5
    v_lshlrev_b32 v6, 2, v3
    v_add_u32 v6, 819200, v6
    v_add_u32 v7, 14336, v6
    s_waitcnt lgkmcnt(0)
    global_load_dwordx4 v[8:11], v4, s[6:7]
    global_load_dwordx4 v[12:15], v4, s[6:7] offset:1024
    global_load_dwordx2 v[24:25], v6, s[8:9]
    global_load_dwordx2 v[28:29], v7, s[8:9]
    v_add_u32 v6, 7168, v6
    v_add_u32 v7, 7168, v7
    global_load_dwordx2 v[26:27], v6, s[8:9]
    global_load_dwordx2 v[30:31], v7, s[8:9]
    s_waitcnt vmcnt(0)
    v_cvt_pk_bf16_f32 v24, v24, v24
    v_and_b32 v24, 0xffff0000, v24
    v_cvt_pk_bf16_f32 v28, v28, v28
    v_and_b32 v28, 0xffff0000, v28
    v_mul_f32 v24, v24, v28
    v_cvt_pk_bf16_f32 v24, v24, v24
    v_and_b32 v24, 0xffff0000, v24
    v_cvt_pk_bf16_f32 v25, v25, v25
    v_and_b32 v25, 0xffff0000, v25
    v_cvt_pk_bf16_f32 v29, v29, v29
    v_and_b32 v29, 0xffff0000, v29
    v_mul_f32 v25, v25, v29
    v_cvt_pk_bf16_f32 v25, v25, v25
    v_and_b32 v25, 0xffff0000, v25
    v_cvt_pk_bf16_f32 v26, v26, v26
    v_and_b32 v26, 0xffff0000, v26
    v_cvt_pk_bf16_f32 v30, v30, v30
    v_and_b32 v30, 0xffff0000, v30
    v_mul_f32 v26, v26, v30
    v_cvt_pk_bf16_f32 v26, v26, v26
    v_and_b32 v26, 0xffff0000, v26
    v_cvt_pk_bf16_f32 v27, v27, v27
    v_and_b32 v27, 0xffff0000, v27
    v_cvt_pk_bf16_f32 v31, v31, v31
    v_and_b32 v31, 0xffff0000, v31
    v_mul_f32 v27, v27, v31
    v_cvt_pk_bf16_f32 v27, v27, v27
    v_and_b32 v27, 0xffff0000, v27
    v_mov_b32 v44, 0
    v_mov_b32 v45, 0
    v_mov_b32 v46, 0
    v_mov_b32 v47, 0
    v_mov_b32 v48, 0
    v_mov_b32 v49, 0
    v_mov_b32 v50, 0
    v_mov_b32 v51, 0
    v_mov_b32 v52, 0
    v_mov_b32 v53, 0
    v_mov_b32 v54, 0
    v_mov_b32 v55, 0
    v_mov_b32 v56, 0
    v_mov_b32 v57, 0
    v_mov_b32 v58, 0
    v_mov_b32 v59, 0
    v_lshlrev_b32 v41, 16, v8
    v_and_b32 v42, 0xffff0000, v8
    v_fmac_f32 v44, v24, v41
    v_fmac_f32 v45, v24, v42
    v_fmac_f32 v52, v26, v41
    v_fmac_f32 v53, v26, v42
    v_lshlrev_b32 v41, 16, v9
    v_and_b32 v42, 0xffff0000, v9
    v_fmac_f32 v46, v24, v41
    v_fmac_f32 v47, v24, v42
    v_fmac_f32 v54, v26, v41
    v_fmac_f32 v55, v26, v42
    v_lshlrev_b32 v41, 16, v10
    v_and_b32 v42, 0xffff0000, v10
    v_fmac_f32 v48, v24, v41
    v_fmac_f32 v49, v24, v42
    v_fmac_f32 v56, v26, v41
    v_fmac_f32 v57, v26, v42
    v_lshlrev_b32 v41, 16, v11
    v_and_b32 v42, 0xffff0000, v11
    v_fmac_f32 v50, v24, v41
    v_fmac_f32 v51, v24, v42
    v_fmac_f32 v58, v26, v41
    v_fmac_f32 v59, v26, v42
    v_lshlrev_b32 v41, 16, v12
    v_and_b32 v42, 0xffff0000, v12
    v_fmac_f32 v44, v25, v41
    v_fmac_f32 v45, v25, v42
    v_fmac_f32 v52, v27, v41
    v_fmac_f32 v53, v27, v42
    v_lshlrev_b32 v41, 16, v13
    v_and_b32 v42, 0xffff0000, v13
    v_fmac_f32 v46, v25, v41
    v_fmac_f32 v47, v25, v42
    v_fmac_f32 v54, v27, v41
    v_fmac_f32 v55, v27, v42
    v_lshlrev_b32 v41, 16, v14
    v_and_b32 v42, 0xffff0000, v14
    v_fmac_f32 v48, v25, v41
    v_fmac_f32 v49, v25, v42
    v_fmac_f32 v56, v27, v41
    v_fmac_f32 v57, v27, v42
    v_lshlrev_b32 v41, 16, v15
    v_and_b32 v42, 0xffff0000, v15
    v_fmac_f32 v50, v25, v41
    v_fmac_f32 v51, v25, v42
    v_fmac_f32 v58, v27, v41
    v_fmac_f32 v59, v27, v42
    v_lshlrev_b32 v60, 6, v0
    v_add_u32 v60, 0, v60
    ds_write_b128 v60, v[44:47] offset:0
    ds_write_b128 v60, v[48:51] offset:16
    ds_write_b128 v60, v[52:55] offset:32
    ds_write_b128 v60, v[56:59] offset:48
    s_waitcnt lgkmcnt(0)
    s_barrier
    v_lshlrev_b32 v60, 2, v0
    v_add_u32 v60, 0, v60
    ds_read_b32 v64, v60 offset:0
    ds_read_b32 v65, v60 offset:512
    ds_read_b32 v66, v60 offset:1024
    ds_read_b32 v67, v60 offset:1536
    ds_read_b32 v68, v60 offset:2048
    ds_read_b32 v69, v60 offset:2560
    ds_read_b32 v70, v60 offset:3072
    ds_read_b32 v71, v60 offset:3584
    ds_read_b32 v72, v60 offset:4096
    ds_read_b32 v73, v60 offset:4608
    ds_read_b32 v74, v60 offset:5120
    ds_read_b32 v75, v60 offset:5632
    ds_read_b32 v76, v60 offset:6144
    ds_read_b32 v77, v60 offset:6656
    ds_read_b32 v78, v60 offset:7168
    ds_read_b32 v79, v60 offset:7680
    ds_read_b32 v80, v60 offset:8192
    ds_read_b32 v81, v60 offset:8704
    ds_read_b32 v82, v60 offset:9216
    ds_read_b32 v83, v60 offset:9728
    ds_read_b32 v84, v60 offset:10240
    ds_read_b32 v85, v60 offset:10752
    ds_read_b32 v86, v60 offset:11264
    ds_read_b32 v87, v60 offset:11776
    ds_read_b32 v88, v60 offset:12288
    ds_read_b32 v89, v60 offset:12800
    ds_read_b32 v90, v60 offset:13312
    ds_read_b32 v91, v60 offset:13824
    ds_read_b32 v92, v60 offset:14336
    ds_read_b32 v93, v60 offset:14848
    ds_read_b32 v94, v60 offset:15360
    ds_read_b32 v95, v60 offset:15872
    s_waitcnt lgkmcnt(0)
    v_add_f32 v40, v64, v65
    v_add_f32 v40, v40, v66
    v_add_f32 v40, v40, v67
    v_add_f32 v40, v40, v68
    v_add_f32 v40, v40, v69
    v_add_f32 v40, v40, v70
    v_add_f32 v40, v40, v71
    v_add_f32 v40, v40, v72
    v_add_f32 v40, v40, v73
    v_add_f32 v40, v40, v74
    v_add_f32 v40, v40, v75
    v_add_f32 v40, v40, v76
    v_add_f32 v40, v40, v77
    v_add_f32 v40, v40, v78
    v_add_f32 v40, v40, v79
    v_add_f32 v40, v40, v80
    v_add_f32 v40, v40, v81
    v_add_f32 v40, v40, v82
    v_add_f32 v40, v40, v83
    v_add_f32 v40, v40, v84
    v_add_f32 v40, v40, v85
    v_add_f32 v40, v40, v86
    v_add_f32 v40, v40, v87
    v_add_f32 v40, v40, v88
    v_add_f32 v40, v40, v89
    v_add_f32 v40, v40, v90
    v_add_f32 v40, v40, v91
    v_add_f32 v40, v40, v92
    v_add_f32 v40, v40, v93
    v_add_f32 v40, v40, v94
    v_add_f32 v40, v40, v95
    v_cmp_gt_u32 vcc, 128, v0
    v_lshrrev_b32 v1, 4, v0
    v_bfe_u32 v2, v0, 3, 1
    v_and_b32 v3, 7, v0
    s_lshl_b32 s15, s11, 6
    v_lshl_add_u32 v4, v1, 3, v3
    v_lshlrev_b32 v5, 9, v2
    v_add3_u32 v4, v4, v5, s15
    v_lshlrev_b32 v4, 2, v4
    v_add_u32 v4, 851968, v4
    s_and_saveexec_b64 s[16:17], vcc
    s_cbranch_execz K6_END
    global_atomic_add_f32 v4, v40, s[8:9]
K6_END:
    s_endpgm
.section .rodata,"a"
.p2align 6
.amdhsa_kernel k6_kernel
  .amdhsa_next_free_vgpr 96
  .amdhsa_next_free_sgpr 102
  .amdhsa_accum_offset 96
  .amdhsa_group_segment_fixed_size 0
  .amdhsa_kernarg_size 112
  .amdhsa_user_sgpr_count 2
  .amdhsa_user_sgpr_kernarg_segment_ptr 1
  .amdhsa_system_sgpr_workgroup_id_x 1
.end_amdhsa_kernel
.text
.globl k7_kernel
.p2align 8
.type k7_kernel,@function
k7_kernel:
    s_cmp_ge_u32 s2, 4
    s_cbranch_scc1 K7_END
    s_load_dwordx2 s[6:7], s[0:1], 88
    s_load_dwordx2 s[8:9], s[0:1], 104
    s_lshl_b32 s10, s2, 8
    v_add_u32 v1, s10, v0
    v_lshlrev_b32 v2, 2, v1
    v_lshrrev_b32 v3, 9, v1
    v_and_b32 v4, 511, v1
    v_mul_u32_u24 v3, 3072, v3
    v_add3_u32 v3, v3, v4, 0
    v_add_u32 v3, 2560, v3
    v_lshlrev_b32 v3, 2, v3
    s_waitcnt lgkmcnt(0)
    v_add_u32 v5, 851968, v2
    global_load_dword v8, v5, s[8:9]
    v_add_u32 v5, 868352, v2
    global_load_dword v9, v5, s[8:9]
    v_add_u32 v5, 884736, v3
    global_load_dword v10, v5, s[8:9]
    s_waitcnt vmcnt(0)
    v_cvt_pk_bf16_f32 v8, v8, v8
    v_and_b32 v8, 0xffff0000, v8
    v_mul_f32 v8, v8, v10
    v_cvt_pk_bf16_f32 v8, v8, v8
    v_and_b32 v8, 0xffff0000, v8
    v_add_f32 v8, v8, v9
    v_cvt_pk_bf16_f32 v8, v8, v8
    v_lshlrev_b32 v1, 1, v1
    global_store_short v1, v8, s[6:7]
K7_END:
    s_endpgm
.section .rodata,"a"
.p2align 6
.amdhsa_kernel k7_kernel
  .amdhsa_next_free_vgpr 32
  .amdhsa_next_free_sgpr 102
  .amdhsa_accum_offset 32
  .amdhsa_group_segment_fixed_size 0
  .amdhsa_kernarg_size 112
  .amdhsa_user_sgpr_count 2
  .amdhsa_user_sgpr_kernarg_segment_ptr 1
  .amdhsa_system_sgpr_workgroup_id_x 1
.end_amdhsa_kernel
```
